```python
import torch

def _softmax(x, axis=-1):
    return torch.softmax(x, dim=axis)
def _gelu(x):
    return torch.nn.functional.gelu(x, approximate="tanh")
def _silu(x):
    return torch.nn.functional.silu(x)
def _sigmoid(x):
    return torch.sigmoid(x)
def _layernorm(x, axis=-1, eps=1e-5):
    m = x.mean(dim=axis, keepdim=True)
    v = x.var(dim=axis, keepdim=True, unbiased=False)
    return (x - m) / torch.sqrt(v + eps)
def _scatter_add(tgt, idx, src, axis=0):
    return tgt.clone().index_add_(axis, idx, src)
def _segment_sum(src, seg, n):
    out = torch.zeros((n,) + src.shape[1:], dtype=src.dtype)
    return out.index_add_(0, seg, src)
def _pad(x, pw):
    flat = tuple(v for pair in reversed(pw) for v in pair)
    return torch.nn.functional.pad(x, flat)

kernel_name = 'standalone__molecular_angular_gemnet__graph'

def setup_inputs():

    _w = (lambda a: (lambda t: t.to(torch.bfloat16) if t.is_floating_point() else t)(torch.as_tensor(a)))
    N, deg, De, L = 10000, 16, 4, 2
    E = N * deg
    T = E * deg
    NR = 8
    dist = torch.rand(E).to(float)
    angle = (torch.rand(T) * torch.pi).to(float)
    centers = torch.linspace(0.0, 1.0, NR).to(float)
    ang_freq = torch.arange(1, L + 1).to(float)
    return {
        "m": _w((lambda *s: torch.randn(*s, dtype=torch.bfloat16) * 0.05)(E, De)),
        "idx_in": _w((lambda lo, hi, *s: torch.randint(lo, hi, s))(0, E, T).to(torch.int64)),
        "idx_out": _w((lambda lo, hi, *s: torch.randint(lo, hi, s))(0, E, T).to(torch.int64)),
        "dist": _w(dist),
        "angle": _w(angle),
        "centers": _w(centers),
        "ang_freq": _w(ang_freq),
        "w_rbf": _w((lambda *s: torch.randn(*s, dtype=torch.bfloat16) * 0.4)(NR, De)),
        "w_sbf": _w((lambda *s: torch.randn(*s, dtype=torch.bfloat16) * 0.4)(NR * L, De)),
        "w_down": _w((lambda *s: torch.randn(*s, dtype=torch.bfloat16) * 0.4)(De, De)),
        "w_up": _w((lambda *s: torch.randn(*s, dtype=torch.bfloat16) * 0.4)(De, De)),
    }

def reference(m, idx_in, idx_out, dist, angle, centers, ang_freq, w_rbf, w_sbf, w_down, w_up):
    E, De = m.shape[0], m.shape[1]
    NR = centers.shape[0]
    L = ang_freq.shape[0]
    rbf = torch.exp(-10.0 * (dist[:, None] - centers[None, :]) ** 2)
    cbf = torch.cos(ang_freq[None, :] * angle[:, None])
    rbf_t = rbf[idx_out]
    sbf = torch.reshape(rbf_t[:, :, None] * cbf[:, None, :], (-1, NR * L))
    x = (m[idx_in] @ w_down) * (sbf @ w_sbf)
    agg = _segment_sum(x, idx_out, E)
    return m + (agg @ w_up) * (rbf @ w_rbf)
```

```asm
; @launch grid=(256,1,1) block=(1024,1,1) lds=163792
.amdgcn_target "amdgcn-amd-amdhsa--gfx950"
.text
.globl standalone__molecular_angular_gemnet__graph_kernel
.p2align 8
.type standalone__molecular_angular_gemnet__graph_kernel,@function
standalone__molecular_angular_gemnet__graph_kernel:
    s_cmp_ge_u32 s2, 256
    s_cbranch_scc1 L_end
    s_load_dwordx4 s[4:7], s[0:1], 8
    s_load_dwordx4 s[8:11], s[0:1], 24
    s_load_dwordx2 s[48:49], s[0:1], 104
    s_load_dwordx2 s[50:51], s[0:1], 0
    s_load_dwordx4 s[96:99], s[0:1], 88
    v_add_u32 v0, 896, v0
    v_and_b32 v0, 0x3ff, v0
    v_lshrrev_b32 v1, 6, v0
    s_mul_i32 s12, s2, 40000
    v_readfirstlane_b32 s3, v1
    s_mul_i32 s13, s2, 20000
    v_lshlrev_b32 v1, 4, v0
    v_lshlrev_b32 v2, 3, v0
    v_lshlrev_b32 v3, 2, v0
    v_mov_b64 v[4:5], 0
    v_mov_b64 v[6:7], 0
    s_movk_i32 s52, 7168
    s_movk_i32 s53, 14336
    s_movk_i32 s54, 28672
    v_cmp_gt_u32 vcc, 708, v0
    s_and_b32 s56, s2, 7
    s_lshl_b32 s56, s56, 5
    s_lshr_b32 s57, s2, 3
    s_add_u32 s56, s56, s57
    s_cmp_ge_u32 s3, 14
    s_cbranch_scc1 L1_side
    s_waitcnt lgkmcnt(0)
    s_add_u32 s16, s6, s12
    s_addc_u32 s17, s7, 0
    s_and_b32 s17, s17, 0xffff
    s_mov_b32 s18, 40000
    s_mov_b32 s19, 0x00020000
    s_mov_b64 s[46:47], vcc
    buffer_load_dwordx4 v[8:11], v1, s[16:19], 0 offen
    buffer_load_dwordx4 v[12:15], v1, s[16:19], s53 offen
    s_mov_b64 exec, s[46:47]
    buffer_load_dwordx4 v[16:19], v1, s[16:19], s54 offen
    s_add_u32 s24, s4, s12
    s_addc_u32 s25, s5, 0
    s_and_b32 s25, s25, 0xffff
    s_mov_b32 s26, 40000
    s_mov_b32 s27, 0x00020000
    s_add_u32 s20, s10, s13
    s_addc_u32 s21, s11, 0
    s_and_b32 s21, s21, 0xffff
    s_mov_b32 s22, 20000
    s_mov_b32 s23, 0x00020000
    s_mov_b64 exec, -1
    s_movk_i32 s44, 0xfd8f
    v_mov_b32 v5, 1
    s_barrier
    s_mul_i32 s45, s2, 10240
    s_add_u32 s45, s45, 64
    s_lshl_b32 s12, s45, 2
    s_add_u32 s12, s12, 0
    s_add_u32 s13, s45, 10489856
    s_add_u32 s28, s48, s12
    s_addc_u32 s29, s49, 0
    s_and_b32 s29, s29, 0xffff
    s_mov_b32 s30, 40000
    s_mov_b32 s31, 0x00020000
    s_add_u32 s32, s48, s13
    s_addc_u32 s33, s49, 0
    s_and_b32 s33, s33, 0xffff
    s_mov_b32 s34, 10000
    s_mov_b32 s35, 0x00020000
    s_add_u32 s36, s48, 16000000
    s_addc_u32 s37, s49, 0
    s_and_b32 s37, s37, 0xffff
    s_mov_b32 s38, 524288
    s_mov_b32 s39, 0x00020000
    s_add_u32 s40, s50, 0
    s_addc_u32 s41, s51, 0
    s_and_b32 s41, s41, 0xffff
    s_or_b32 s41, s41, 524288
    s_mov_b32 s42, 160000
    s_mov_b32 s43, 0x00020000
    s_mul_i32 s14, s56, 128
    s_add_u32 s15, s14, 262144
    v_add_u32 v62, 16384, v1
    v_add_u32 v63, 32768, v1
    s_waitcnt vmcnt(2)
    buffer_load_dwordx4 v[20:23], v1, s[24:27], 0 offen
    v_mul_hi_u32_u24 v38, 6871948, v8
    v_mul_hi_u32_u24 v39, 6871948, v9
    v_mul_hi_u32_u24 v40, 6871948, v10
    v_mul_hi_u32_u24 v41, 6871948, v11
    v_mad_i32_i24 v8, v38, s44, v8
    v_lshlrev_b32 v38, 2, v38
    v_mad_i32_i24 v9, v39, s44, v9
    v_lshlrev_b32 v39, 2, v39
    v_mad_i32_i24 v10, v40, s44, v10
    v_lshlrev_b32 v40, 2, v40
    v_mad_i32_i24 v11, v41, s44, v11
    v_lshlrev_b32 v41, 2, v41
    ds_add_rtn_u32 v50, v38, v5 offset:33792
    ds_add_rtn_u32 v51, v39, v5 offset:33792
    ds_add_rtn_u32 v52, v40, v5 offset:33792
    ds_add_rtn_u32 v53, v41, v5 offset:33792
    s_waitcnt vmcnt(2)
    buffer_load_dwordx4 v[24:27], v1, s[24:27], s53 offen
    v_mul_hi_u32_u24 v42, 6871948, v12
    v_mul_hi_u32_u24 v43, 6871948, v13
    v_mul_hi_u32_u24 v44, 6871948, v14
    v_mul_hi_u32_u24 v45, 6871948, v15
    v_mad_i32_i24 v12, v42, s44, v12
    v_lshlrev_b32 v42, 2, v42
    v_mad_i32_i24 v13, v43, s44, v13
    v_lshlrev_b32 v43, 2, v43
    v_mad_i32_i24 v14, v44, s44, v14
    v_lshlrev_b32 v44, 2, v44
    v_mad_i32_i24 v15, v45, s44, v15
    v_lshlrev_b32 v45, 2, v45
    ds_add_rtn_u32 v54, v42, v5 offset:33792
    ds_add_rtn_u32 v55, v43, v5 offset:33792
    ds_add_rtn_u32 v56, v44, v5 offset:33792
    ds_add_rtn_u32 v57, v45, v5 offset:33792
    s_mov_b64 exec, s[46:47]
    s_waitcnt vmcnt(2)
    buffer_load_dwordx4 v[28:31], v1, s[24:27], s54 offen
    v_mul_hi_u32_u24 v46, 6871948, v16
    v_mul_hi_u32_u24 v47, 6871948, v17
    v_mul_hi_u32_u24 v48, 6871948, v18
    v_mul_hi_u32_u24 v49, 6871948, v19
    v_mad_i32_i24 v16, v46, s44, v16
    v_lshlrev_b32 v46, 2, v46
    v_mad_i32_i24 v17, v47, s44, v17
    v_lshlrev_b32 v47, 2, v47
    v_mad_i32_i24 v18, v48, s44, v18
    v_lshlrev_b32 v48, 2, v48
    v_mad_i32_i24 v19, v49, s44, v19
    v_lshlrev_b32 v49, 2, v49
    ds_add_rtn_u32 v58, v46, v5 offset:33792
    ds_add_rtn_u32 v59, v47, v5 offset:33792
    ds_add_rtn_u32 v60, v48, v5 offset:33792
    ds_add_rtn_u32 v61, v49, v5 offset:33792
    s_mov_b64 exec, -1
    s_mov_b32 s16, s8
    s_and_b32 s17, s9, 0xffff
    s_mov_b32 s18, 320000
    s_mov_b32 s19, 0x00020000
    s_mul_i32 s60, s56, 625
    v_add_u32 v109, s60, v0
    v_lshlrev_b32 v64, 1, v109
    v_cmp_gt_u32 vcc, 625, v0
    s_mov_b64 exec, vcc
    buffer_load_ushort v108, v64, s[16:19], 0 offen
    buffer_load_dwordx2 v[98:99], v109, s[40:43], 0 idxen
    s_mov_b64 exec, -1
    v_and_b32 v6, 63, v0
    v_lshlrev_b32 v6, 4, v6
    s_waitcnt lgkmcnt(0)
    s_barrier
    buffer_load_dwordx2 v[32:33], v2, s[20:23], 0 offen
    buffer_load_dwordx2 v[34:35], v2, s[20:23], s52 offen
    s_mov_b64 exec, s[46:47]
    buffer_load_dwordx2 v[36:37], v2, s[20:23], s53 offen
    s_mov_b64 exec, -1
    ds_read_b128 v[64:67], v6 offset:33792
    s_waitcnt lgkmcnt(0)
    v_add_u32 v69, v64, v65
    v_add_u32 v70, v69, v66
    v_add_u32 v71, v70, v67
    v_mov_b32 v72, v71
    s_nop 1
    v_add_u32_dpp v72, v72, v72 row_shr:1 row_mask:0xf bank_mask:0xf bound_ctrl:0
    s_nop 1
    v_add_u32_dpp v72, v72, v72 row_shr:2 row_mask:0xf bank_mask:0xf bound_ctrl:0
    s_nop 1
    v_add_u32_dpp v72, v72, v72 row_shr:4 row_mask:0xf bank_mask:0xf bound_ctrl:0
    s_nop 1
    v_add_u32_dpp v72, v72, v72 row_shr:8 row_mask:0xf bank_mask:0xf bound_ctrl:0
    s_nop 1
    v_add_u32_dpp v72, v72, v72 row_bcast:15 row_mask:0xa bank_mask:0xf
    s_nop 1
    v_add_u32_dpp v72, v72, v72 row_bcast:31 row_mask:0xc bank_mask:0xf
    v_sub_u32 v72, v72, v71
    v_add_u32 v73, v72, v64
    v_add_u32 v74, v72, v69
    v_add_u32 v75, v72, v70
    ds_write_b128 v6, v[72:75] offset:34816
    ds_read_b32 v6, v3 offset:33792
    ds_read_b32 v7, v3 offset:34816
    ds_read_b32 v38, v38 offset:34816
    ds_read_b32 v39, v39 offset:34816
    ds_read_b32 v40, v40 offset:34816
    ds_read_b32 v41, v41 offset:34816
    ds_read_b32 v42, v42 offset:34816
    ds_read_b32 v43, v43 offset:34816
    ds_read_b32 v44, v44 offset:34816
    ds_read_b32 v45, v45 offset:34816
    s_mov_b64 exec, s[46:47]
    ds_read_b32 v46, v46 offset:34816
    ds_read_b32 v47, v47 offset:34816
    ds_read_b32 v48, v48 offset:34816
    ds_read_b32 v49, v49 offset:34816
    s_mov_b64 exec, -1
    s_waitcnt lgkmcnt(12)
    v_add_u32 v7, s45, v7
    v_min_u32 v74, 0x3ff, v6
    v_lshl_or_b32 v7, v7, 10, v74
    v_lshlrev_b32 v4, 2, v0
    v_and_b32 v4, 0x7c, v4
    v_lshrrev_b32 v5, 5, v0
    v_lshl_or_b32 v4, v5, 15, v4
    v_mov_b32 v5, 0x40a00000
    s_mov_b32 s10, 0x3ffc00
    s_waitcnt lgkmcnt(8)
    v_add_u32 v50, v50, v38
    v_add_u32 v51, v51, v39
    v_add_u32 v52, v52, v40
    v_add_u32 v53, v53, v41
    s_waitcnt vmcnt(7)
    v_mul_hi_u32_u24 v38, 6871948, v20
    v_mul_hi_u32_u24 v39, 6871948, v21
    v_mul_hi_u32_u24 v40, 6871948, v22
    v_mul_hi_u32_u24 v41, 6871948, v23
    v_mad_i32_i24 v20, v38, s44, v20
    v_mad_i32_i24 v21, v39, s44, v21
    v_mad_i32_i24 v22, v40, s44, v22
    v_mad_i32_i24 v23, v41, s44, v23
    v_lshl_or_b32 v20, v8, 22, v20
    v_lshlrev_b32 v8, 2, v50
    v_lshl_or_b32 v21, v9, 22, v21
    v_lshlrev_b32 v9, 2, v51
    v_lshl_or_b32 v22, v10, 22, v22
    v_lshlrev_b32 v10, 2, v52
    v_lshl_or_b32 v23, v11, 22, v23
    v_lshlrev_b32 v11, 2, v53
    s_waitcnt lgkmcnt(4)
    v_add_u32 v54, v54, v42
    v_add_u32 v55, v55, v43
    v_add_u32 v56, v56, v44
    v_add_u32 v57, v57, v45
    s_waitcnt vmcnt(6)
    v_mul_hi_u32_u24 v42, 6871948, v24
    v_mul_hi_u32_u24 v43, 6871948, v25
    v_mul_hi_u32_u24 v44, 6871948, v26
    v_mul_hi_u32_u24 v45, 6871948, v27
    v_mad_i32_i24 v24, v42, s44, v24
    v_mad_i32_i24 v25, v43, s44, v25
    v_mad_i32_i24 v26, v44, s44, v26
    v_mad_i32_i24 v27, v45, s44, v27
    v_lshl_or_b32 v24, v12, 22, v24
    v_lshlrev_b32 v12, 2, v54
    v_lshl_or_b32 v25, v13, 22, v25
    v_lshlrev_b32 v13, 2, v55
    v_lshl_or_b32 v26, v14, 22, v26
    v_lshlrev_b32 v14, 2, v56
    v_lshl_or_b32 v27, v15, 22, v27
    v_lshlrev_b32 v15, 2, v57
    s_mov_b64 exec, s[46:47]
    s_waitcnt lgkmcnt(0)
    v_add_u32 v58, v58, v46
    v_add_u32 v59, v59, v47
    v_add_u32 v60, v60, v48
    v_add_u32 v61, v61, v49
    s_waitcnt vmcnt(5)
    v_mul_hi_u32_u24 v46, 6871948, v28
    v_mul_hi_u32_u24 v47, 6871948, v29
    v_mul_hi_u32_u24 v48, 6871948, v30
    v_mul_hi_u32_u24 v49, 6871948, v31
    v_mad_i32_i24 v28, v46, s44, v28
    v_mad_i32_i24 v29, v47, s44, v29
    v_mad_i32_i24 v30, v48, s44, v30
    v_mad_i32_i24 v31, v49, s44, v31
    v_lshl_or_b32 v28, v16, 22, v28
    v_lshlrev_b32 v16, 2, v58
    v_lshl_or_b32 v29, v17, 22, v29
    v_lshlrev_b32 v17, 2, v59
    v_lshl_or_b32 v30, v18, 22, v30
    v_lshlrev_b32 v18, 2, v60
    v_lshl_or_b32 v31, v19, 22, v31
    v_lshlrev_b32 v19, 2, v61
    s_mov_b64 exec, -1
    s_waitcnt vmcnt(2)
    v_lshlrev_b32 v64, 16, v32
    v_and_b32 v65, 0xffff0000, v32
    v_lshlrev_b32 v66, 16, v33
    v_and_b32 v67, 0xffff0000, v33
    v_mul_f32 v64, 0.15915494, v64
    v_mul_f32 v65, 0.15915494, v65
    v_mul_f32 v66, 0.15915494, v66
    v_mul_f32 v67, 0.15915494, v67
    v_fract_f32 v64, v64
    v_fract_f32 v65, v65
    v_fract_f32 v66, v66
    v_fract_f32 v67, v67
    v_cos_f32 v64, v64
    v_cos_f32 v65, v65
    v_cos_f32 v66, v66
    v_cos_f32 v67, v67
    v_fmamk_f32 v64, v64, 0x3f7ff000, v5
    v_fmamk_f32 v65, v65, 0x3f7ff000, v5
    v_fmamk_f32 v66, v66, 0x3f7ff000, v5
    v_fmamk_f32 v67, v67, 0x3f7ff000, v5
    v_and_or_b32 v20, v64, s10, v20
    v_and_or_b32 v21, v65, s10, v21
    v_and_or_b32 v22, v66, s10, v22
    v_and_or_b32 v23, v67, s10, v23
    ds_write_b32 v8, v20 offset:35840
    ds_write_b32 v9, v21 offset:35840
    ds_write_b32 v10, v22 offset:35840
    ds_write_b32 v11, v23 offset:35840
    s_waitcnt vmcnt(1)
    v_lshlrev_b32 v64, 16, v34
    v_and_b32 v65, 0xffff0000, v34
    v_lshlrev_b32 v66, 16, v35
    v_and_b32 v67, 0xffff0000, v35
    v_mul_f32 v64, 0.15915494, v64
    v_mul_f32 v65, 0.15915494, v65
    v_mul_f32 v66, 0.15915494, v66
    v_mul_f32 v67, 0.15915494, v67
    v_fract_f32 v64, v64
    v_fract_f32 v65, v65
    v_fract_f32 v66, v66
    v_fract_f32 v67, v67
    v_cos_f32 v64, v64
    v_cos_f32 v65, v65
    v_cos_f32 v66, v66
    v_cos_f32 v67, v67
    v_fmamk_f32 v64, v64, 0x3f7ff000, v5
    v_fmamk_f32 v65, v65, 0x3f7ff000, v5
    v_fmamk_f32 v66, v66, 0x3f7ff000, v5
    v_fmamk_f32 v67, v67, 0x3f7ff000, v5
    v_and_or_b32 v24, v64, s10, v24
    v_and_or_b32 v25, v65, s10, v25
    v_and_or_b32 v26, v66, s10, v26
    v_and_or_b32 v27, v67, s10, v27
    ds_write_b32 v12, v24 offset:35840
    ds_write_b32 v13, v25 offset:35840
    ds_write_b32 v14, v26 offset:35840
    ds_write_b32 v15, v27 offset:35840
    s_mov_b64 exec, s[46:47]
    s_waitcnt vmcnt(0)
    v_lshlrev_b32 v64, 16, v36
    v_and_b32 v65, 0xffff0000, v36
    v_lshlrev_b32 v66, 16, v37
    v_and_b32 v67, 0xffff0000, v37
    v_mul_f32 v64, 0.15915494, v64
    v_mul_f32 v65, 0.15915494, v65
    v_mul_f32 v66, 0.15915494, v66
    v_mul_f32 v67, 0.15915494, v67
    v_fract_f32 v64, v64
    v_fract_f32 v65, v65
    v_fract_f32 v66, v66
    v_fract_f32 v67, v67
    v_cos_f32 v64, v64
    v_cos_f32 v65, v65
    v_cos_f32 v66, v66
    v_cos_f32 v67, v67
    v_fmamk_f32 v64, v64, 0x3f7ff000, v5
    v_fmamk_f32 v65, v65, 0x3f7ff000, v5
    v_fmamk_f32 v66, v66, 0x3f7ff000, v5
    v_fmamk_f32 v67, v67, 0x3f7ff000, v5
    v_and_or_b32 v28, v64, s10, v28
    v_and_or_b32 v29, v65, s10, v29
    v_and_or_b32 v30, v66, s10, v30
    v_and_or_b32 v31, v67, s10, v31
    ds_write_b32 v16, v28 offset:35840
    ds_write_b32 v17, v29 offset:35840
    ds_write_b32 v18, v30 offset:35840
    ds_write_b32 v19, v31 offset:35840
    s_mov_b64 exec, -1
    s_waitcnt lgkmcnt(0)
L1_cpa:
    s_barrier
    ds_read_b128 v[76:79], v1 offset:35840
    ds_read_b128 v[80:83], v62 offset:35840
    ds_read_b128 v[84:87], v63 offset:35840
    s_waitcnt lgkmcnt(2)
    buffer_store_dwordx4 v[76:79], v1, s[28:31], 0 offen sc1
    s_waitcnt lgkmcnt(1)
    buffer_store_dwordx4 v[80:83], v62, s[28:31], 0 offen sc1
    s_waitcnt lgkmcnt(0)
    buffer_store_dwordx4 v[84:87], v63, s[28:31], 0 offen sc1
    s_cmp_ge_u32 s3, 14
    s_cbranch_scc1 L1_cpb
    ds_write_b8 v50, v38 offset:23792
    ds_write_b8 v51, v39 offset:23792
    ds_write_b8 v52, v40 offset:23792
    ds_write_b8 v53, v41 offset:23792
    ds_write_b8 v54, v42 offset:23792
    ds_write_b8 v55, v43 offset:23792
    ds_write_b8 v56, v44 offset:23792
    ds_write_b8 v57, v45 offset:23792
    s_mov_b64 exec, s[46:47]
    ds_write_b8 v58, v46 offset:23792
    ds_write_b8 v59, v47 offset:23792
    ds_write_b8 v60, v48 offset:23792
    ds_write_b8 v61, v49 offset:23792
    s_mov_b64 exec, -1
    s_waitcnt lgkmcnt(0)
L1_cpb:
    s_barrier
    ds_read_b128 v[88:91], v1 offset:23792
    s_waitcnt lgkmcnt(0)
    buffer_store_dwordx4 v[88:91], v1, s[32:35], 0 offen sc1
    v_and_b32 v65, 31, v0
    v_lshlrev_b32 v65, 3, v65
    ds_read_b64 v[96:97], v65 offset:23536
    v_and_b32 v2, 63, v0
    v_lshlrev_b32 v1, 2, v2
    v_and_b32 v13, 15, v0
    v_mul_u32_u24 v12, 128, v13
    s_lshl_b32 s44, s56, 2
    s_and_b32 s44, s44, 0x7c
    s_lshr_b32 s60, s56, 5
    s_lshl_b32 s60, s60, 15
    s_add_u32 s44, s44, s60
    s_mul_i32 s60, s3, 2048
    s_add_u32 s44, s44, s60
    s_mov_b32 s45, 0
    s_cmp_ge_u32 s3, 4
    s_cbranch_scc1 L1_nofl
    v_cmp_lt_u32 vcc, 60, v6
    s_cbranch_vccz L1_nofl
    s_mov_b64 exec, vcc
    buffer_store_dword v6, v4, s[36:39], s15 offen sc1
L1_nofl:
    s_mov_b64 exec, -1
    v_mul_u32_u24 v15, 1040, v2
    v_mov_b32 v40, 0x40800000
    v_mov_b32 v41, 0xc0a00801
    v_mov_b32 v42, 625
    s_mov_b32 s10, 0x3ffc00
    v_mov_b32 v3, -5000
    v_lshlrev_b32 v5, 2, v13
    v_mov_b32 v14, 1040
    v_mov_b64 v[8:9], 0
    v_mov_b64 v[10:11], 0
    s_mov_b32 s52, 0
    s_mov_b32 s53, 0
    s_mov_b32 s54, 23792
    s_mov_b32 s57, 90352
    s_and_b32 s9, s56, 0
    s_mov_b32 s55, 22512
    s_mov_b32 s59, 0
    s_add_u32 s32, s48, 0
    s_addc_u32 s33, s49, 0
    s_and_b32 s33, s33, 0xffff
    s_mov_b32 s34, 10489856
    s_mov_b32 s35, 0x00020000
    s_add_u32 s4, s48, 10489856
    s_addc_u32 s5, s49, 0
    s_and_b32 s5, s5, 0xffff
    s_mov_b32 s6, 2700000
    s_mov_b32 s7, 0x00020000
    s_add_u32 s16, s48, 0
    s_addc_u32 s17, s49, 0
    s_and_b32 s17, s17, 0xffff
    s_or_b32 s17, s17, 1048576
    s_mov_b32 s18, 655616
    s_mov_b32 s19, 0x00020000
    s_add_u32 s20, s48, 10489856
    s_addc_u32 s21, s49, 0
    s_and_b32 s21, s21, 0xffff
    s_or_b32 s21, s21, 262144
    s_mov_b32 s22, 675000
    s_mov_b32 s23, 0x00020000
    s_cmp_ge_u32 s3, 10
    s_cbranch_scc1 L1_fl
    v_lshlrev_b32 v108, 16, v108
    v_subrev_f32 v68, 0x00000000, v108
    v_subrev_f32 v69, 0x3e120000, v108
    v_subrev_f32 v70, 0x3e920000, v108
    v_subrev_f32 v71, 0x3edb0000, v108
    v_subrev_f32 v72, 0x3f120000, v108
    v_subrev_f32 v73, 0x3f370000, v108
    v_subrev_f32 v74, 0x3f5b0000, v108
    v_subrev_f32 v75, 0x3f800000, v108
    v_cvt_pk_bf16_f32 v104, v68, v69
    v_cvt_pk_bf16_f32 v105, v70, v71
    v_cvt_pk_bf16_f32 v106, v72, v73
    v_cvt_pk_bf16_f32 v107, v74, v75
    v_lshlrev_b32 v68, 16, v104
    v_and_b32 v69, 0xffff0000, v104
    v_lshlrev_b32 v70, 16, v105
    v_and_b32 v71, 0xffff0000, v105
    v_lshlrev_b32 v72, 16, v106
    v_and_b32 v73, 0xffff0000, v106
    v_lshlrev_b32 v74, 16, v107
    v_and_b32 v75, 0xffff0000, v107
    v_pk_mul_f32 v[68:69], v[68:69], v[68:69]
    v_pk_mul_f32 v[70:71], v[70:71], v[70:71]
    v_pk_mul_f32 v[72:73], v[72:73], v[72:73]
    v_pk_mul_f32 v[74:75], v[74:75], v[74:75]
    v_cvt_pk_bf16_f32 v104, v68, v69
    v_cvt_pk_bf16_f32 v105, v70, v71
    v_cvt_pk_bf16_f32 v106, v72, v73
    v_cvt_pk_bf16_f32 v107, v74, v75
    v_lshlrev_b32 v68, 16, v104
    v_and_b32 v69, 0xffff0000, v104
    v_lshlrev_b32 v70, 16, v105
    v_and_b32 v71, 0xffff0000, v105
    v_lshlrev_b32 v72, 16, v106
    v_and_b32 v73, 0xffff0000, v106
    v_lshlrev_b32 v74, 16, v107
    v_and_b32 v75, 0xffff0000, v107
    v_mul_f32 v68, 0xc1200000, v68
    v_mul_f32 v69, 0xc1200000, v69
    v_mul_f32 v70, 0xc1200000, v70
    v_mul_f32 v71, 0xc1200000, v71
    v_mul_f32 v72, 0xc1200000, v72
    v_mul_f32 v73, 0xc1200000, v73
    v_mul_f32 v74, 0xc1200000, v74
    v_mul_f32 v75, 0xc1200000, v75
    v_cvt_pk_bf16_f32 v104, v68, v69
    v_cvt_pk_bf16_f32 v105, v70, v71
    v_cvt_pk_bf16_f32 v106, v72, v73
    v_cvt_pk_bf16_f32 v107, v74, v75
    v_lshlrev_b32 v68, 16, v104
    v_and_b32 v69, 0xffff0000, v104
    v_lshlrev_b32 v70, 16, v105
    v_and_b32 v71, 0xffff0000, v105
    v_lshlrev_b32 v72, 16, v106
    v_and_b32 v73, 0xffff0000, v106
    v_lshlrev_b32 v74, 16, v107
    v_and_b32 v75, 0xffff0000, v107
    v_mul_f32 v68, 0x3fb8aa3b, v68
    v_mul_f32 v69, 0x3fb8aa3b, v69
    v_mul_f32 v70, 0x3fb8aa3b, v70
    v_mul_f32 v71, 0x3fb8aa3b, v71
    v_mul_f32 v72, 0x3fb8aa3b, v72
    v_mul_f32 v73, 0x3fb8aa3b, v73
    v_mul_f32 v74, 0x3fb8aa3b, v74
    v_mul_f32 v75, 0x3fb8aa3b, v75
    v_exp_f32 v68, v68
    v_exp_f32 v69, v69
    v_exp_f32 v70, v70
    v_exp_f32 v71, v71
    v_exp_f32 v72, v72
    v_exp_f32 v73, v73
    v_exp_f32 v74, v74
    v_exp_f32 v75, v75
    s_nop 0
    v_cvt_pk_bf16_f32 v104, v68, v69
    v_cvt_pk_bf16_f32 v105, v70, v71
    v_cvt_pk_bf16_f32 v106, v72, v73
    v_cvt_pk_bf16_f32 v107, v74, v75
    s_waitcnt lgkmcnt(0)
    v_mfma_f32_4x4x4_16b_bf16 v[68:71], v[96:97], v[104:105], 0 cbsz:4 abid:0
    v_mfma_f32_4x4x4_16b_bf16 v[72:75], v[96:97], v[104:105], 0 cbsz:4 abid:2
    v_mfma_f32_4x4x4_16b_bf16 v[100:103], v[96:97], v[104:105], 0 cbsz:4 abid:4
    v_mfma_f32_4x4x4_16b_bf16 v[68:71], v[96:97], v[106:107], v[68:71] cbsz:4 abid:1
    v_mfma_f32_4x4x4_16b_bf16 v[72:75], v[96:97], v[106:107], v[72:75] cbsz:4 abid:3
    v_mfma_f32_4x4x4_16b_bf16 v[100:103], v[96:97], v[106:107], v[100:103] cbsz:4 abid:5
    v_lshlrev_b32 v76, 3, v0
    v_add_u32 v76, 158792, v76
    v_lshlrev_b32 v77, 4, v0
    v_lshlrev_b32 v78, 2, v0
    v_cmp_gt_u32 vcc, 625, v0
    s_mov_b64 exec, vcc
    v_pk_add_f32 v[72:73], v[72:73], v[72:73]
    v_pk_add_f32 v[74:75], v[74:75], v[74:75]
    v_cvt_pk_bf16_f32 v68, v68, v72
    v_cvt_pk_bf16_f32 v69, v69, v73
    v_cvt_pk_bf16_f32 v70, v70, v74
    v_cvt_pk_bf16_f32 v71, v71, v75
    ds_write_b128 v77, v[68:71] offset:0
    ds_write_b32 v78, v76 offset:10000
    s_mov_b64 exec, -1
L2_noag:
    s_cmp_ge_u32 s3, 4
    s_waitcnt vmcnt(0) lgkmcnt(0)
    s_barrier
    s_cbranch_scc1 L1_nopub
    buffer_store_dword v7, v4, s[36:39], s14 offen sc1
    s_branch L1_pubd
L1_nopub:
    ds_write_b128 v15, v[8:11] offset:24816
L1_pubd:
    s_lshl_b32 s15, s3, 6
    s_add_u32 s15, s15, 23792
    v_add_u32 v15, s15, v15
    s_mov_b64 exec, 0xffff
    buffer_load_dword v110, v12, s[36:39], s44 offen sc1
    s_waitcnt vmcnt(0)
L2_round:
    s_mov_b64 exec, 0xffff
    v_cmp_ne_u32 vcc, 0, v110
    s_mov_b32 s25, vcc_lo
    s_andn2_b32 s58, vcc_lo, s59
    s_bcnt1_i32_b32 s12, s58
    s_and_b32 s12, s12, 28
    s_cbranch_scc0 L2_repoll

    s_mov_b64 exec, -1
    v_mov_b32 v92, 60
    s_mov_b32 exec_lo, s58
    s_mov_b32 exec_hi, 0
    v_mbcnt_lo_u32_b32 v68, s58, 0
    v_cmp_gt_u32 vcc, s12, v68
    v_and_b32 v69, 3, v68
    s_sub_u32 s60, 16, s12
    v_and_b32 v68, 12, v68
    v_add_u32 v68, s60, v68
    v_lshl_or_b32 v92, v69, 6, v68
    s_or_b32 s59, s59, vcc_lo
    s_mov_b64 exec, -1
    ds_permute_b32 v92, v92, v110
    s_waitcnt lgkmcnt(0)
    s_cmp_lt_u32 s12, 16
    s_cbranch_scc1 L2_g0_e
    v_mov_b32_dpp v93, v92 row_newbcast:0 row_mask:0xf bank_mask:0xf
    v_and_b32 v68, 0x3ff, v93
    v_bfe_u32 v69, v93, 10, 2
    v_lshrrev_b32 v70, 12, v93
    v_cmp_lt_u32 vcc, 60, v68
    v_min_u32 v68, 60, v68
    v_sub_u32 v69, v5, v69
    v_add_u32 v70, v70, v13
    s_cbranch_vccnz L2_x0
L2_x0_r:
    v_cmp_lt_i32 vcc, v69, v68
    s_mov_b64 exec, vcc
    buffer_load_dword v32, v70, s[20:23], 0 idxen sc1
    buffer_load_dwordx4 v[16:19], v70, s[16:19], 0 idxen sc1
    s_mov_b64 exec, -1
    v_cmp_lt_u32 s[64:65], v69, v68
    v_add_u32 v69, 1, v69
    v_cmp_lt_u32 s[66:67], v69, v68
    v_add_u32 v69, 1, v69
    v_cmp_lt_u32 s[68:69], v69, v68
    v_add_u32 v69, 1, v69
    v_cmp_lt_u32 s[70:71], v69, v68
L2_g0_e:
    s_cmp_lt_u32 s12, 12
    s_cbranch_scc1 L2_g1_e
    v_mov_b32_dpp v93, v92 row_newbcast:1 row_mask:0xf bank_mask:0xf
    v_and_b32 v68, 0x3ff, v93
    v_bfe_u32 v69, v93, 10, 2
    v_lshrrev_b32 v70, 12, v93
    v_cmp_lt_u32 vcc, 60, v68
    v_min_u32 v68, 60, v68
    v_sub_u32 v69, v5, v69
    v_add_u32 v70, v70, v13
    s_cbranch_vccnz L2_x1
L2_x1_r:
    v_cmp_lt_i32 vcc, v69, v68
    s_mov_b64 exec, vcc
    buffer_load_dword v33, v70, s[20:23], 0 idxen sc1
    buffer_load_dwordx4 v[20:23], v70, s[16:19], 0 idxen sc1
    s_mov_b64 exec, -1
    v_cmp_lt_u32 s[72:73], v69, v68
    v_add_u32 v69, 1, v69
    v_cmp_lt_u32 s[74:75], v69, v68
    v_add_u32 v69, 1, v69
    v_cmp_lt_u32 s[76:77], v69, v68
    v_add_u32 v69, 1, v69
    v_cmp_lt_u32 s[78:79], v69, v68
L2_g1_e:
    s_cmp_lt_u32 s12, 8
    s_cbranch_scc1 L2_g2_e
    v_mov_b32_dpp v93, v92 row_newbcast:2 row_mask:0xf bank_mask:0xf
    v_and_b32 v68, 0x3ff, v93
    v_bfe_u32 v69, v93, 10, 2
    v_lshrrev_b32 v70, 12, v93
    v_cmp_lt_u32 vcc, 60, v68
    v_min_u32 v68, 60, v68
    v_sub_u32 v69, v5, v69
    v_add_u32 v70, v70, v13
    s_cbranch_vccnz L2_x2
L2_x2_r:
    v_cmp_lt_i32 vcc, v69, v68
    s_mov_b64 exec, vcc
    buffer_load_dword v34, v70, s[20:23], 0 idxen sc1
    buffer_load_dwordx4 v[24:27], v70, s[16:19], 0 idxen sc1
    s_mov_b64 exec, -1
    v_cmp_lt_u32 s[80:81], v69, v68
    v_add_u32 v69, 1, v69
    v_cmp_lt_u32 s[82:83], v69, v68
    v_add_u32 v69, 1, v69
    v_cmp_lt_u32 s[84:85], v69, v68
    v_add_u32 v69, 1, v69
    v_cmp_lt_u32 s[86:87], v69, v68
L2_g2_e:
    v_mov_b32_dpp v93, v92 row_newbcast:3 row_mask:0xf bank_mask:0xf
    v_and_b32 v68, 0x3ff, v93
    v_bfe_u32 v69, v93, 10, 2
    v_lshrrev_b32 v70, 12, v93
    v_cmp_lt_u32 vcc, 60, v68
    v_min_u32 v68, 60, v68
    v_sub_u32 v69, v5, v69
    v_add_u32 v70, v70, v13
    s_cbranch_vccnz L2_x3
L2_x3_r:
    v_cmp_lt_i32 vcc, v69, v68
    s_mov_b64 exec, vcc
    buffer_load_dword v35, v70, s[20:23], 0 idxen sc1
    buffer_load_dwordx4 v[28:31], v70, s[16:19], 0 idxen sc1
    s_mov_b64 exec, -1
    v_cmp_lt_u32 s[88:89], v69, v68
    v_add_u32 v69, 1, v69
    v_cmp_lt_u32 s[90:91], v69, v68
    v_add_u32 v69, 1, v69
    v_cmp_lt_u32 s[92:93], v69, v68
    v_add_u32 v69, 1, v69
    v_cmp_lt_u32 s[94:95], v69, v68
L2_g3_e:
    s_andn2_b32 exec_lo, 0xffff, s25
    s_mov_b32 exec_hi, 0
    buffer_load_dword v110, v12, s[36:39], s44 offen sc1
L2_pld:
    s_cmp_lt_u32 s12, 16
    s_cbranch_scc1 L2_h0_e
    s_waitcnt vmcnt(8)
    s_mov_b64 exec, s[64:65]
    v_lshlrev_b32_sdwa v68, 2, v32 dst_sel:DWORD dst_unused:UNUSED_PAD src0_sel:DWORD src1_sel:BYTE_0
    ds_add_rtn_u32 v68, v68, v14 offset:22512
    s_mov_b64 exec, s[66:67]
    v_lshlrev_b32_sdwa v69, 2, v32 dst_sel:DWORD dst_unused:UNUSED_PAD src0_sel:DWORD src1_sel:BYTE_1
    ds_add_rtn_u32 v69, v69, v14 offset:22512
    s_mov_b64 exec, s[68:69]
    v_lshlrev_b32_sdwa v70, 2, v32 dst_sel:DWORD dst_unused:UNUSED_PAD src0_sel:DWORD src1_sel:BYTE_2
    ds_add_rtn_u32 v70, v70, v14 offset:22512
    s_mov_b64 exec, s[70:71]
    v_lshlrev_b32_sdwa v71, 2, v32 dst_sel:DWORD dst_unused:UNUSED_PAD src0_sel:DWORD src1_sel:BYTE_3
    ds_add_rtn_u32 v71, v71, v14 offset:22512
    s_waitcnt vmcnt(7)
    s_mov_b64 exec, s[64:65]
    s_waitcnt lgkmcnt(3)
    v_cmp_le_u32 vcc, s57, v68
    s_cbranch_vccnz L2_s0_o
L2_s0_r:
    ds_write_b32 v68, v16
    s_mov_b64 exec, s[66:67]
    s_waitcnt lgkmcnt(3)
    v_cmp_le_u32 vcc, s57, v69
    s_cbranch_vccnz L2_s1_o
L2_s1_r:
    ds_write_b32 v69, v17
    s_mov_b64 exec, s[68:69]
    s_waitcnt lgkmcnt(3)
    v_cmp_le_u32 vcc, s57, v70
    s_cbranch_vccnz L2_s2_o
L2_s2_r:
    ds_write_b32 v70, v18
    s_mov_b64 exec, s[70:71]
    s_waitcnt lgkmcnt(3)
    v_cmp_le_u32 vcc, s57, v71
    s_cbranch_vccnz L2_s3_o
L2_s3_r:
    ds_write_b32 v71, v19
L2_h0_e:
    s_cmp_lt_u32 s12, 12
    s_cbranch_scc1 L2_h1_e
    s_waitcnt vmcnt(6)
    s_mov_b64 exec, s[72:73]
    v_lshlrev_b32_sdwa v68, 2, v33 dst_sel:DWORD dst_unused:UNUSED_PAD src0_sel:DWORD src1_sel:BYTE_0
    ds_add_rtn_u32 v68, v68, v14 offset:22512
    s_mov_b64 exec, s[74:75]
    v_lshlrev_b32_sdwa v69, 2, v33 dst_sel:DWORD dst_unused:UNUSED_PAD src0_sel:DWORD src1_sel:BYTE_1
    ds_add_rtn_u32 v69, v69, v14 offset:22512
    s_mov_b64 exec, s[76:77]
    v_lshlrev_b32_sdwa v70, 2, v33 dst_sel:DWORD dst_unused:UNUSED_PAD src0_sel:DWORD src1_sel:BYTE_2
    ds_add_rtn_u32 v70, v70, v14 offset:22512
    s_mov_b64 exec, s[78:79]
    v_lshlrev_b32_sdwa v71, 2, v33 dst_sel:DWORD dst_unused:UNUSED_PAD src0_sel:DWORD src1_sel:BYTE_3
    ds_add_rtn_u32 v71, v71, v14 offset:22512
    s_waitcnt vmcnt(5)
    s_mov_b64 exec, s[72:73]
    s_waitcnt lgkmcnt(3)
    v_cmp_le_u32 vcc, s57, v68
    s_cbranch_vccnz L2_s4_o
L2_s4_r:
    ds_write_b32 v68, v20
    s_mov_b64 exec, s[74:75]
    s_waitcnt lgkmcnt(3)
    v_cmp_le_u32 vcc, s57, v69
    s_cbranch_vccnz L2_s5_o
L2_s5_r:
    ds_write_b32 v69, v21
    s_mov_b64 exec, s[76:77]
    s_waitcnt lgkmcnt(3)
    v_cmp_le_u32 vcc, s57, v70
    s_cbranch_vccnz L2_s6_o
L2_s6_r:
    ds_write_b32 v70, v22
    s_mov_b64 exec, s[78:79]
    s_waitcnt lgkmcnt(3)
    v_cmp_le_u32 vcc, s57, v71
    s_cbranch_vccnz L2_s7_o
L2_s7_r:
    ds_write_b32 v71, v23
L2_h1_e:
    s_cmp_lt_u32 s12, 8
    s_cbranch_scc1 L2_h2_e
    s_waitcnt vmcnt(4)
    s_mov_b64 exec, s[80:81]
    v_lshlrev_b32_sdwa v68, 2, v34 dst_sel:DWORD dst_unused:UNUSED_PAD src0_sel:DWORD src1_sel:BYTE_0
    ds_add_rtn_u32 v68, v68, v14 offset:22512
    s_mov_b64 exec, s[82:83]
    v_lshlrev_b32_sdwa v69, 2, v34 dst_sel:DWORD dst_unused:UNUSED_PAD src0_sel:DWORD src1_sel:BYTE_1
    ds_add_rtn_u32 v69, v69, v14 offset:22512
    s_mov_b64 exec, s[84:85]
    v_lshlrev_b32_sdwa v70, 2, v34 dst_sel:DWORD dst_unused:UNUSED_PAD src0_sel:DWORD src1_sel:BYTE_2
    ds_add_rtn_u32 v70, v70, v14 offset:22512
    s_mov_b64 exec, s[86:87]
    v_lshlrev_b32_sdwa v71, 2, v34 dst_sel:DWORD dst_unused:UNUSED_PAD src0_sel:DWORD src1_sel:BYTE_3
    ds_add_rtn_u32 v71, v71, v14 offset:22512
    s_waitcnt vmcnt(3)
    s_mov_b64 exec, s[80:81]
    s_waitcnt lgkmcnt(3)
    v_cmp_le_u32 vcc, s57, v68
    s_cbranch_vccnz L2_s8_o
L2_s8_r:
    ds_write_b32 v68, v24
    s_mov_b64 exec, s[82:83]
    s_waitcnt lgkmcnt(3)
    v_cmp_le_u32 vcc, s57, v69
    s_cbranch_vccnz L2_s9_o
L2_s9_r:
    ds_write_b32 v69, v25
    s_mov_b64 exec, s[84:85]
    s_waitcnt lgkmcnt(3)
    v_cmp_le_u32 vcc, s57, v70
    s_cbranch_vccnz L2_s10_o
L2_s10_r:
    ds_write_b32 v70, v26
    s_mov_b64 exec, s[86:87]
    s_waitcnt lgkmcnt(3)
    v_cmp_le_u32 vcc, s57, v71
    s_cbranch_vccnz L2_s11_o
L2_s11_r:
    ds_write_b32 v71, v27
L2_h2_e:
    s_waitcnt vmcnt(2)
    s_mov_b64 exec, s[88:89]
    v_lshlrev_b32_sdwa v68, 2, v35 dst_sel:DWORD dst_unused:UNUSED_PAD src0_sel:DWORD src1_sel:BYTE_0
    ds_add_rtn_u32 v68, v68, v14 offset:22512
    s_mov_b64 exec, s[90:91]
    v_lshlrev_b32_sdwa v69, 2, v35 dst_sel:DWORD dst_unused:UNUSED_PAD src0_sel:DWORD src1_sel:BYTE_1
    ds_add_rtn_u32 v69, v69, v14 offset:22512
    s_mov_b64 exec, s[92:93]
    v_lshlrev_b32_sdwa v70, 2, v35 dst_sel:DWORD dst_unused:UNUSED_PAD src0_sel:DWORD src1_sel:BYTE_2
    ds_add_rtn_u32 v70, v70, v14 offset:22512
    s_mov_b64 exec, s[94:95]
    v_lshlrev_b32_sdwa v71, 2, v35 dst_sel:DWORD dst_unused:UNUSED_PAD src0_sel:DWORD src1_sel:BYTE_3
    ds_add_rtn_u32 v71, v71, v14 offset:22512
    s_waitcnt vmcnt(1)
    s_mov_b64 exec, s[88:89]
    s_waitcnt lgkmcnt(3)
    v_cmp_le_u32 vcc, s57, v68
    s_cbranch_vccnz L2_s12_o
L2_s12_r:
    ds_write_b32 v68, v28
    s_mov_b64 exec, s[90:91]
    s_waitcnt lgkmcnt(3)
    v_cmp_le_u32 vcc, s57, v69
    s_cbranch_vccnz L2_s13_o
L2_s13_r:
    ds_write_b32 v69, v29
    s_mov_b64 exec, s[92:93]
    s_waitcnt lgkmcnt(3)
    v_cmp_le_u32 vcc, s57, v70
    s_cbranch_vccnz L2_s14_o
L2_s14_r:
    ds_write_b32 v70, v30
    s_mov_b64 exec, s[94:95]
    s_waitcnt lgkmcnt(3)
    v_cmp_le_u32 vcc, s57, v71
    s_cbranch_vccnz L2_s15_o
L2_s15_r:
    ds_write_b32 v71, v31
L2_h3_e:
    s_cmp_eq_u32 s59, 0xffff
    s_cbranch_scc1 L2_sorted
    s_waitcnt vmcnt(0)
    s_branch L2_round
L2_sorted:
    s_cmp_eq_u32 s52, 0
    s_cbranch_scc1 L2_nox
    s_waitcnt vmcnt(0)
    s_bfm_b64 exec, s52, 0
    v_lshlrev_b32_sdwa v68, 2, v49 dst_sel:DWORD dst_unused:UNUSED_PAD src0_sel:DWORD src1_sel:BYTE_0
    ds_add_rtn_u32 v68, v68, v14 offset:22512
    s_waitcnt lgkmcnt(0)
    v_cmp_le_u32 vcc, s57, v68
    s_cbranch_vccnz L2_s16_o
L2_s16_r:
    ds_write_b32 v68, v48
L2_nox:
    s_mov_b64 exec, -1
    s_lshl_b32 s15, s3, 6
    s_add_u32 s15, s15, 22512
    v_mov_b32 v60, s15
    v_add_u32 v61, 63, v15
    v_lshrrev_b32 v62, 2, v15
    v_add_u32 v62, 84404, v62
    s_mul_i32 s24, s3, 0x10101010
    s_add_u32 s24, s24, 0x03020100
    s_add_u32 s25, s24, 0x04040404
    s_add_u32 s26, s24, 0x08080808
    s_add_u32 s27, s24, 0x0c0c0c0c
    s_waitcnt lgkmcnt(0)
    s_barrier
    ds_read2_b32 v[32:33], v62 offset0:0 offset1:1
    ds_read_b128 v[68:71], v60 offset:0
    ds_read_b128 v[16:19], v15 offset:0
    ds_read_b128 v[72:75], v60 offset:16
    ds_read_b128 v[20:23], v15 offset:16
    ds_read2_b32 v[34:35], v62 offset0:2 offset1:3
    ds_read_b128 v[76:79], v60 offset:32
    ds_read_b128 v[24:27], v15 offset:32
    ds_read_b128 v[80:83], v60 offset:48
    ds_read_b128 v[28:31], v15 offset:48
    s_waitcnt lgkmcnt(8)
    v_xor_b32 v32, s24, v32
    v_cmp_lt_u32 s[64:65], v61, v68
    v_cmp_lt_u32 s[66:67], v61, v69
    v_cmp_lt_u32 s[68:69], v61, v70
    v_cmp_lt_u32 s[70:71], v61, v71
    s_waitcnt lgkmcnt(7)
    s_mov_b64 exec, s[64:65]
    v_and_b32 v50, 0x3ff, v16
    v_mul_u32_u24_sdwa v51, v42, v32 dst_sel:DWORD dst_unused:UNUSED_PAD src0_sel:DWORD src1_sel:BYTE_0
    v_add_u32 v50, v50, v51
    buffer_load_dwordx2 v[50:51], v50, s[40:43], 0 idxen
    s_mov_b64 exec, s[66:67]
    v_and_b32 v52, 0x3ff, v17
    v_mul_u32_u24_sdwa v53, v42, v32 dst_sel:DWORD dst_unused:UNUSED_PAD src0_sel:DWORD src1_sel:BYTE_1
    v_add_u32 v52, v52, v53
    buffer_load_dwordx2 v[52:53], v52, s[40:43], 0 idxen
    s_mov_b64 exec, s[68:69]
    v_and_b32 v54, 0x3ff, v18
    v_mul_u32_u24_sdwa v55, v42, v32 dst_sel:DWORD dst_unused:UNUSED_PAD src0_sel:DWORD src1_sel:BYTE_2
    v_add_u32 v54, v54, v55
    buffer_load_dwordx2 v[54:55], v54, s[40:43], 0 idxen
    s_mov_b64 exec, -1
    s_waitcnt lgkmcnt(6)
    v_xor_b32 v33, s25, v33
    v_cmp_lt_u32 s[72:73], v61, v72
    v_cmp_lt_u32 s[74:75], v61, v73
    v_cmp_lt_u32 s[76:77], v61, v74
    v_cmp_lt_u32 s[78:79], v61, v75
    s_mov_b64 exec, -1
    s_waitcnt lgkmcnt(3)
    v_xor_b32 v34, s26, v34
    v_cmp_lt_u32 s[80:81], v61, v76
    v_cmp_lt_u32 s[82:83], v61, v77
    v_cmp_lt_u32 s[84:85], v61, v78
    v_cmp_lt_u32 s[86:87], v61, v79
    s_mov_b64 exec, -1
    s_waitcnt lgkmcnt(1)
    v_xor_b32 v35, s27, v35
    v_cmp_lt_u32 s[88:89], v61, v80
    v_cmp_lt_u32 s[90:91], v61, v81
    v_cmp_lt_u32 s[92:93], v61, v82
    v_cmp_lt_u32 s[94:95], v61, v83
    s_mov_b64 exec, -1
    ds_write_b128 v15, v[8:11] offset:0
    ds_write_b128 v15, v[8:11] offset:16
    ds_write_b128 v15, v[8:11] offset:32
    ds_write_b128 v15, v[8:11] offset:48
    ds_write2_b32 v62, v8, v9 offset0:0 offset1:1
    ds_write2_b32 v62, v8, v9 offset0:2 offset1:3
    s_waitcnt lgkmcnt(0)
    s_barrier
    s_setprio 3
    s_mov_b64 exec, s[64:65]
    v_lshrrev_b32 v60, 22, v16
    v_lshlrev_b32 v58, 2, v60
    v_lshlrev_b32 v60, 4, v60
    ds_add_rtn_u32 v58, v58, v3 offset:10000
    ds_read_b128 v[60:63], v60
    v_and_or_b32 v44, v16, s10, v40
    v_fmamk_f32 v44, v44, 0x3f800801, v41
    v_fma_f32 v46, v44, v44, -0.5
    v_cvt_pk_bf16_f32 v44, v44, v46
    s_mov_b64 exec, s[66:67]
    v_lshrrev_b32 v64, 22, v17
    v_lshlrev_b32 v59, 2, v64
    v_lshlrev_b32 v64, 4, v64
    ds_add_rtn_u32 v59, v59, v3 offset:10000
    ds_read_b128 v[64:67], v64
    v_and_or_b32 v45, v17, s10, v40
    v_fmamk_f32 v45, v45, 0x3f800801, v41
    v_fma_f32 v46, v45, v45, -0.5
    v_cvt_pk_bf16_f32 v45, v45, v46
    s_mov_b64 exec, s[64:65]
    s_waitcnt vmcnt(2)
    v_mfma_f32_4x4x4_16b_bf16 v[72:75], v[96:97], v[50:51], 0 cbsz:4 abid:7
    s_waitcnt lgkmcnt(2)
    v_dot2_f32_bf16 v68, v60, v44, 0
    v_dot2_f32_bf16 v69, v61, v44, 0
    v_dot2_f32_bf16 v70, v62, v44, 0
    v_dot2_f32_bf16 v71, v63, v44, 0
    v_cmp_gt_i32 vcc, s54, v58
    s_nop 0
    v_pk_mul_f32 v[68:69], v[68:69], v[72:73]
    v_pk_mul_f32 v[70:71], v[70:71], v[74:75]
    s_cbranch_vccnz L2_p0_o
L2_p0_r:
    v_cvt_pk_bf16_f32 v76, v68, v69
    v_cvt_pk_bf16_f32 v77, v70, v71
    ds_write_b64 v58, v[76:77]
    s_mov_b64 exec, s[70:71]
    v_and_b32 v56, 0x3ff, v19
    v_mul_u32_u24_sdwa v57, v42, v32 dst_sel:DWORD dst_unused:UNUSED_PAD src0_sel:DWORD src1_sel:BYTE_3
    v_add_u32 v56, v56, v57
    buffer_load_dwordx2 v[56:57], v56, s[40:43], 0 idxen
    s_mov_b64 exec, s[68:69]
    v_lshrrev_b32 v60, 22, v18
    v_lshlrev_b32 v58, 2, v60
    v_lshlrev_b32 v60, 4, v60
    ds_add_rtn_u32 v58, v58, v3 offset:10000
    ds_read_b128 v[60:63], v60
    v_and_or_b32 v44, v18, s10, v40
    v_fmamk_f32 v44, v44, 0x3f800801, v41
    v_fma_f32 v46, v44, v44, -0.5
    v_cvt_pk_bf16_f32 v44, v44, v46
    s_mov_b64 exec, s[66:67]
    s_waitcnt vmcnt(2)
    v_mfma_f32_4x4x4_16b_bf16 v[72:75], v[96:97], v[52:53], 0 cbsz:4 abid:7
    s_waitcnt lgkmcnt(3)
    v_dot2_f32_bf16 v68, v64, v45, 0
    v_dot2_f32_bf16 v69, v65, v45, 0
    v_dot2_f32_bf16 v70, v66, v45, 0
    v_dot2_f32_bf16 v71, v67, v45, 0
    v_cmp_gt_i32 vcc, s54, v59
    s_nop 0
    v_pk_mul_f32 v[68:69], v[68:69], v[72:73]
    v_pk_mul_f32 v[70:71], v[70:71], v[74:75]
    s_cbranch_vccnz L2_p1_o
L2_p1_r:
    v_cvt_pk_bf16_f32 v76, v68, v69
    v_cvt_pk_bf16_f32 v77, v70, v71
    ds_write_b64 v59, v[76:77]
    s_mov_b64 exec, s[72:73]
    v_and_b32 v50, 0x3ff, v20
    v_mul_u32_u24_sdwa v51, v42, v33 dst_sel:DWORD dst_unused:UNUSED_PAD src0_sel:DWORD src1_sel:BYTE_0
    v_add_u32 v50, v50, v51
    buffer_load_dwordx2 v[50:51], v50, s[40:43], 0 idxen
    s_mov_b64 exec, s[70:71]
    v_lshrrev_b32 v64, 22, v19
    v_lshlrev_b32 v59, 2, v64
    v_lshlrev_b32 v64, 4, v64
    ds_add_rtn_u32 v59, v59, v3 offset:10000
    ds_read_b128 v[64:67], v64
    v_and_or_b32 v45, v19, s10, v40
    v_fmamk_f32 v45, v45, 0x3f800801, v41
    v_fma_f32 v46, v45, v45, -0.5
    v_cvt_pk_bf16_f32 v45, v45, v46
    s_mov_b64 exec, s[68:69]
    s_waitcnt vmcnt(2)
    v_mfma_f32_4x4x4_16b_bf16 v[72:75], v[96:97], v[54:55], 0 cbsz:4 abid:7
    s_waitcnt lgkmcnt(3)
    v_dot2_f32_bf16 v68, v60, v44, 0
    v_dot2_f32_bf16 v69, v61, v44, 0
    v_dot2_f32_bf16 v70, v62, v44, 0
    v_dot2_f32_bf16 v71, v63, v44, 0
    v_cmp_gt_i32 vcc, s54, v58
    s_nop 0
    v_pk_mul_f32 v[68:69], v[68:69], v[72:73]
    v_pk_mul_f32 v[70:71], v[70:71], v[74:75]
    s_cbranch_vccnz L2_p2_o
L2_p2_r:
    v_cvt_pk_bf16_f32 v76, v68, v69
    v_cvt_pk_bf16_f32 v77, v70, v71
    ds_write_b64 v58, v[76:77]
    s_mov_b64 exec, s[74:75]
    v_and_b32 v52, 0x3ff, v21
    v_mul_u32_u24_sdwa v53, v42, v33 dst_sel:DWORD dst_unused:UNUSED_PAD src0_sel:DWORD src1_sel:BYTE_1
    v_add_u32 v52, v52, v53
    buffer_load_dwordx2 v[52:53], v52, s[40:43], 0 idxen
    s_mov_b64 exec, s[72:73]
    v_lshrrev_b32 v60, 22, v20
    v_lshlrev_b32 v58, 2, v60
    v_lshlrev_b32 v60, 4, v60
    ds_add_rtn_u32 v58, v58, v3 offset:10000
    ds_read_b128 v[60:63], v60
    v_and_or_b32 v44, v20, s10, v40
    v_fmamk_f32 v44, v44, 0x3f800801, v41
    v_fma_f32 v46, v44, v44, -0.5
    v_cvt_pk_bf16_f32 v44, v44, v46
    s_mov_b64 exec, s[70:71]
    s_waitcnt vmcnt(2)
    v_mfma_f32_4x4x4_16b_bf16 v[72:75], v[96:97], v[56:57], 0 cbsz:4 abid:7
    s_waitcnt lgkmcnt(3)
    v_dot2_f32_bf16 v68, v64, v45, 0
    v_dot2_f32_bf16 v69, v65, v45, 0
    v_dot2_f32_bf16 v70, v66, v45, 0
    v_dot2_f32_bf16 v71, v67, v45, 0
    v_cmp_gt_i32 vcc, s54, v59
    s_nop 0
    v_pk_mul_f32 v[68:69], v[68:69], v[72:73]
    v_pk_mul_f32 v[70:71], v[70:71], v[74:75]
    s_cbranch_vccnz L2_p3_o
L2_p3_r:
    v_cvt_pk_bf16_f32 v76, v68, v69
    v_cvt_pk_bf16_f32 v77, v70, v71
    ds_write_b64 v59, v[76:77]
    s_mov_b64 exec, s[76:77]
    v_and_b32 v54, 0x3ff, v22
    v_mul_u32_u24_sdwa v55, v42, v33 dst_sel:DWORD dst_unused:UNUSED_PAD src0_sel:DWORD src1_sel:BYTE_2
    v_add_u32 v54, v54, v55
    buffer_load_dwordx2 v[54:55], v54, s[40:43], 0 idxen
    s_mov_b64 exec, s[74:75]
    v_lshrrev_b32 v64, 22, v21
    v_lshlrev_b32 v59, 2, v64
    v_lshlrev_b32 v64, 4, v64
    ds_add_rtn_u32 v59, v59, v3 offset:10000
    ds_read_b128 v[64:67], v64
    v_and_or_b32 v45, v21, s10, v40
    v_fmamk_f32 v45, v45, 0x3f800801, v41
    v_fma_f32 v46, v45, v45, -0.5
    v_cvt_pk_bf16_f32 v45, v45, v46
    s_mov_b64 exec, s[72:73]
    s_waitcnt vmcnt(2)
    v_mfma_f32_4x4x4_16b_bf16 v[72:75], v[96:97], v[50:51], 0 cbsz:4 abid:7
    s_waitcnt lgkmcnt(3)
    v_dot2_f32_bf16 v68, v60, v44, 0
    v_dot2_f32_bf16 v69, v61, v44, 0
    v_dot2_f32_bf16 v70, v62, v44, 0
    v_dot2_f32_bf16 v71, v63, v44, 0
    v_cmp_gt_i32 vcc, s54, v58
    s_nop 0
    v_pk_mul_f32 v[68:69], v[68:69], v[72:73]
    v_pk_mul_f32 v[70:71], v[70:71], v[74:75]
    s_cbranch_vccnz L2_p4_o
L2_p4_r:
    v_cvt_pk_bf16_f32 v76, v68, v69
    v_cvt_pk_bf16_f32 v77, v70, v71
    ds_write_b64 v58, v[76:77]
    s_mov_b64 exec, s[78:79]
    v_and_b32 v56, 0x3ff, v23
    v_mul_u32_u24_sdwa v57, v42, v33 dst_sel:DWORD dst_unused:UNUSED_PAD src0_sel:DWORD src1_sel:BYTE_3
    v_add_u32 v56, v56, v57
    buffer_load_dwordx2 v[56:57], v56, s[40:43], 0 idxen
    s_mov_b64 exec, s[76:77]
    v_lshrrev_b32 v60, 22, v22
    v_lshlrev_b32 v58, 2, v60
    v_lshlrev_b32 v60, 4, v60
    ds_add_rtn_u32 v58, v58, v3 offset:10000
    ds_read_b128 v[60:63], v60
    v_and_or_b32 v44, v22, s10, v40
    v_fmamk_f32 v44, v44, 0x3f800801, v41
    v_fma_f32 v46, v44, v44, -0.5
    v_cvt_pk_bf16_f32 v44, v44, v46
    s_mov_b64 exec, s[74:75]
    s_waitcnt vmcnt(2)
    v_mfma_f32_4x4x4_16b_bf16 v[72:75], v[96:97], v[52:53], 0 cbsz:4 abid:7
    s_waitcnt lgkmcnt(3)
    v_dot2_f32_bf16 v68, v64, v45, 0
    v_dot2_f32_bf16 v69, v65, v45, 0
    v_dot2_f32_bf16 v70, v66, v45, 0
    v_dot2_f32_bf16 v71, v67, v45, 0
    v_cmp_gt_i32 vcc, s54, v59
    s_nop 0
    v_pk_mul_f32 v[68:69], v[68:69], v[72:73]
    v_pk_mul_f32 v[70:71], v[70:71], v[74:75]
    s_cbranch_vccnz L2_p5_o
L2_p5_r:
    v_cvt_pk_bf16_f32 v76, v68, v69
    v_cvt_pk_bf16_f32 v77, v70, v71
    ds_write_b64 v59, v[76:77]
    s_mov_b64 exec, s[80:81]
    v_and_b32 v50, 0x3ff, v24
    v_mul_u32_u24_sdwa v51, v42, v34 dst_sel:DWORD dst_unused:UNUSED_PAD src0_sel:DWORD src1_sel:BYTE_0
    v_add_u32 v50, v50, v51
    buffer_load_dwordx2 v[50:51], v50, s[40:43], 0 idxen
    s_mov_b64 exec, s[78:79]
    v_lshrrev_b32 v64, 22, v23
    v_lshlrev_b32 v59, 2, v64
    v_lshlrev_b32 v64, 4, v64
    ds_add_rtn_u32 v59, v59, v3 offset:10000
    ds_read_b128 v[64:67], v64
    v_and_or_b32 v45, v23, s10, v40
    v_fmamk_f32 v45, v45, 0x3f800801, v41
    v_fma_f32 v46, v45, v45, -0.5
    v_cvt_pk_bf16_f32 v45, v45, v46
    s_mov_b64 exec, s[76:77]
    s_waitcnt vmcnt(2)
    v_mfma_f32_4x4x4_16b_bf16 v[72:75], v[96:97], v[54:55], 0 cbsz:4 abid:7
    s_waitcnt lgkmcnt(3)
    v_dot2_f32_bf16 v68, v60, v44, 0
    v_dot2_f32_bf16 v69, v61, v44, 0
    v_dot2_f32_bf16 v70, v62, v44, 0
    v_dot2_f32_bf16 v71, v63, v44, 0
    v_cmp_gt_i32 vcc, s54, v58
    s_nop 0
    v_pk_mul_f32 v[68:69], v[68:69], v[72:73]
    v_pk_mul_f32 v[70:71], v[70:71], v[74:75]
    s_cbranch_vccnz L2_p6_o
L2_p6_r:
    v_cvt_pk_bf16_f32 v76, v68, v69
    v_cvt_pk_bf16_f32 v77, v70, v71
    ds_write_b64 v58, v[76:77]
    s_mov_b64 exec, s[82:83]
    v_and_b32 v52, 0x3ff, v25
    v_mul_u32_u24_sdwa v53, v42, v34 dst_sel:DWORD dst_unused:UNUSED_PAD src0_sel:DWORD src1_sel:BYTE_1
    v_add_u32 v52, v52, v53
    buffer_load_dwordx2 v[52:53], v52, s[40:43], 0 idxen
    s_mov_b64 exec, s[80:81]
    v_lshrrev_b32 v60, 22, v24
    v_lshlrev_b32 v58, 2, v60
    v_lshlrev_b32 v60, 4, v60
    ds_add_rtn_u32 v58, v58, v3 offset:10000
    ds_read_b128 v[60:63], v60
    v_and_or_b32 v44, v24, s10, v40
    v_fmamk_f32 v44, v44, 0x3f800801, v41
    v_fma_f32 v46, v44, v44, -0.5
    v_cvt_pk_bf16_f32 v44, v44, v46
    s_mov_b64 exec, s[78:79]
    s_waitcnt vmcnt(2)
    v_mfma_f32_4x4x4_16b_bf16 v[72:75], v[96:97], v[56:57], 0 cbsz:4 abid:7
    s_waitcnt lgkmcnt(3)
    v_dot2_f32_bf16 v68, v64, v45, 0
    v_dot2_f32_bf16 v69, v65, v45, 0
    v_dot2_f32_bf16 v70, v66, v45, 0
    v_dot2_f32_bf16 v71, v67, v45, 0
    v_cmp_gt_i32 vcc, s54, v59
    s_nop 0
    v_pk_mul_f32 v[68:69], v[68:69], v[72:73]
    v_pk_mul_f32 v[70:71], v[70:71], v[74:75]
    s_cbranch_vccnz L2_p7_o
L2_p7_r:
    v_cvt_pk_bf16_f32 v76, v68, v69
    v_cvt_pk_bf16_f32 v77, v70, v71
    ds_write_b64 v59, v[76:77]
    s_mov_b64 exec, s[84:85]
    v_and_b32 v54, 0x3ff, v26
    v_mul_u32_u24_sdwa v55, v42, v34 dst_sel:DWORD dst_unused:UNUSED_PAD src0_sel:DWORD src1_sel:BYTE_2
    v_add_u32 v54, v54, v55
    buffer_load_dwordx2 v[54:55], v54, s[40:43], 0 idxen
    s_setprio 2
    s_mov_b64 exec, s[82:83]
    v_lshrrev_b32 v64, 22, v25
    v_lshlrev_b32 v59, 2, v64
    v_lshlrev_b32 v64, 4, v64
    ds_add_rtn_u32 v59, v59, v3 offset:10000
    ds_read_b128 v[64:67], v64
    v_and_or_b32 v45, v25, s10, v40
    v_fmamk_f32 v45, v45, 0x3f800801, v41
    v_fma_f32 v46, v45, v45, -0.5
    v_cvt_pk_bf16_f32 v45, v45, v46
    s_mov_b64 exec, s[80:81]
    s_waitcnt vmcnt(2)
    v_mfma_f32_4x4x4_16b_bf16 v[72:75], v[96:97], v[50:51], 0 cbsz:4 abid:7
    s_waitcnt lgkmcnt(3)
    v_dot2_f32_bf16 v68, v60, v44, 0
    v_dot2_f32_bf16 v69, v61, v44, 0
    v_dot2_f32_bf16 v70, v62, v44, 0
    v_dot2_f32_bf16 v71, v63, v44, 0
    v_cmp_gt_i32 vcc, s54, v58
    s_nop 0
    v_pk_mul_f32 v[68:69], v[68:69], v[72:73]
    v_pk_mul_f32 v[70:71], v[70:71], v[74:75]
    s_cbranch_vccnz L2_p8_o
L2_p8_r:
    v_cvt_pk_bf16_f32 v76, v68, v69
    v_cvt_pk_bf16_f32 v77, v70, v71
    ds_write_b64 v58, v[76:77]
    s_mov_b64 exec, s[86:87]
    v_and_b32 v56, 0x3ff, v27
    v_mul_u32_u24_sdwa v57, v42, v34 dst_sel:DWORD dst_unused:UNUSED_PAD src0_sel:DWORD src1_sel:BYTE_3
    v_add_u32 v56, v56, v57
    buffer_load_dwordx2 v[56:57], v56, s[40:43], 0 idxen
    s_mov_b64 exec, s[84:85]
    v_lshrrev_b32 v60, 22, v26
    v_lshlrev_b32 v58, 2, v60
    v_lshlrev_b32 v60, 4, v60
    ds_add_rtn_u32 v58, v58, v3 offset:10000
    ds_read_b128 v[60:63], v60
    v_and_or_b32 v44, v26, s10, v40
    v_fmamk_f32 v44, v44, 0x3f800801, v41
    v_fma_f32 v46, v44, v44, -0.5
    v_cvt_pk_bf16_f32 v44, v44, v46
    s_mov_b64 exec, s[82:83]
    s_waitcnt vmcnt(2)
    v_mfma_f32_4x4x4_16b_bf16 v[72:75], v[96:97], v[52:53], 0 cbsz:4 abid:7
    s_waitcnt lgkmcnt(3)
    v_dot2_f32_bf16 v68, v64, v45, 0
    v_dot2_f32_bf16 v69, v65, v45, 0
    v_dot2_f32_bf16 v70, v66, v45, 0
    v_dot2_f32_bf16 v71, v67, v45, 0
    v_cmp_gt_i32 vcc, s54, v59
    s_nop 0
    v_pk_mul_f32 v[68:69], v[68:69], v[72:73]
    v_pk_mul_f32 v[70:71], v[70:71], v[74:75]
    s_cbranch_vccnz L2_p9_o
L2_p9_r:
    v_cvt_pk_bf16_f32 v76, v68, v69
    v_cvt_pk_bf16_f32 v77, v70, v71
    ds_write_b64 v59, v[76:77]
    s_mov_b64 exec, s[88:89]
    v_and_b32 v50, 0x3ff, v28
    v_mul_u32_u24_sdwa v51, v42, v35 dst_sel:DWORD dst_unused:UNUSED_PAD src0_sel:DWORD src1_sel:BYTE_0
    v_add_u32 v50, v50, v51
    buffer_load_dwordx2 v[50:51], v50, s[40:43], 0 idxen
    s_mov_b64 exec, s[86:87]
    v_lshrrev_b32 v64, 22, v27
    v_lshlrev_b32 v59, 2, v64
    v_lshlrev_b32 v64, 4, v64
    ds_add_rtn_u32 v59, v59, v3 offset:10000
    ds_read_b128 v[64:67], v64
    v_and_or_b32 v45, v27, s10, v40
    v_fmamk_f32 v45, v45, 0x3f800801, v41
    v_fma_f32 v46, v45, v45, -0.5
    v_cvt_pk_bf16_f32 v45, v45, v46
    s_mov_b64 exec, s[84:85]
    s_waitcnt vmcnt(2)
    v_mfma_f32_4x4x4_16b_bf16 v[72:75], v[96:97], v[54:55], 0 cbsz:4 abid:7
    s_waitcnt lgkmcnt(3)
    v_dot2_f32_bf16 v68, v60, v44, 0
    v_dot2_f32_bf16 v69, v61, v44, 0
    v_dot2_f32_bf16 v70, v62, v44, 0
    v_dot2_f32_bf16 v71, v63, v44, 0
    v_cmp_gt_i32 vcc, s54, v58
    s_nop 0
    v_pk_mul_f32 v[68:69], v[68:69], v[72:73]
    v_pk_mul_f32 v[70:71], v[70:71], v[74:75]
    s_cbranch_vccnz L2_p10_o
L2_p10_r:
    v_cvt_pk_bf16_f32 v76, v68, v69
    v_cvt_pk_bf16_f32 v77, v70, v71
    ds_write_b64 v58, v[76:77]
    s_mov_b64 exec, s[90:91]
    v_and_b32 v52, 0x3ff, v29
    v_mul_u32_u24_sdwa v53, v42, v35 dst_sel:DWORD dst_unused:UNUSED_PAD src0_sel:DWORD src1_sel:BYTE_1
    v_add_u32 v52, v52, v53
    buffer_load_dwordx2 v[52:53], v52, s[40:43], 0 idxen
    s_setprio 1
    s_mov_b64 exec, s[88:89]
    v_lshrrev_b32 v60, 22, v28
    v_lshlrev_b32 v58, 2, v60
    v_lshlrev_b32 v60, 4, v60
    ds_add_rtn_u32 v58, v58, v3 offset:10000
    ds_read_b128 v[60:63], v60
    v_and_or_b32 v44, v28, s10, v40
    v_fmamk_f32 v44, v44, 0x3f800801, v41
    v_fma_f32 v46, v44, v44, -0.5
    v_cvt_pk_bf16_f32 v44, v44, v46
    s_mov_b64 exec, s[86:87]
    s_waitcnt vmcnt(2)
    v_mfma_f32_4x4x4_16b_bf16 v[72:75], v[96:97], v[56:57], 0 cbsz:4 abid:7
    s_waitcnt lgkmcnt(3)
    v_dot2_f32_bf16 v68, v64, v45, 0
    v_dot2_f32_bf16 v69, v65, v45, 0
    v_dot2_f32_bf16 v70, v66, v45, 0
    v_dot2_f32_bf16 v71, v67, v45, 0
    v_cmp_gt_i32 vcc, s54, v59
    s_nop 0
    v_pk_mul_f32 v[68:69], v[68:69], v[72:73]
    v_pk_mul_f32 v[70:71], v[70:71], v[74:75]
    s_cbranch_vccnz L2_p11_o
L2_p11_r:
    v_cvt_pk_bf16_f32 v76, v68, v69
    v_cvt_pk_bf16_f32 v77, v70, v71
    ds_write_b64 v59, v[76:77]
    s_mov_b64 exec, s[92:93]
    v_and_b32 v54, 0x3ff, v30
    v_mul_u32_u24_sdwa v55, v42, v35 dst_sel:DWORD dst_unused:UNUSED_PAD src0_sel:DWORD src1_sel:BYTE_2
    v_add_u32 v54, v54, v55
    buffer_load_dwordx2 v[54:55], v54, s[40:43], 0 idxen
    s_mov_b64 exec, s[90:91]
    v_lshrrev_b32 v64, 22, v29
    v_lshlrev_b32 v59, 2, v64
    v_lshlrev_b32 v64, 4, v64
    ds_add_rtn_u32 v59, v59, v3 offset:10000
    ds_read_b128 v[64:67], v64
    v_and_or_b32 v45, v29, s10, v40
    v_fmamk_f32 v45, v45, 0x3f800801, v41
    v_fma_f32 v46, v45, v45, -0.5
    v_cvt_pk_bf16_f32 v45, v45, v46
    s_mov_b64 exec, s[88:89]
    s_waitcnt vmcnt(2)
    v_mfma_f32_4x4x4_16b_bf16 v[72:75], v[96:97], v[50:51], 0 cbsz:4 abid:7
    s_waitcnt lgkmcnt(3)
    v_dot2_f32_bf16 v68, v60, v44, 0
    v_dot2_f32_bf16 v69, v61, v44, 0
    v_dot2_f32_bf16 v70, v62, v44, 0
    v_dot2_f32_bf16 v71, v63, v44, 0
    v_cmp_gt_i32 vcc, s54, v58
    s_nop 0
    v_pk_mul_f32 v[68:69], v[68:69], v[72:73]
    v_pk_mul_f32 v[70:71], v[70:71], v[74:75]
    s_cbranch_vccnz L2_p12_o
L2_p12_r:
    v_cvt_pk_bf16_f32 v76, v68, v69
    v_cvt_pk_bf16_f32 v77, v70, v71
    ds_write_b64 v58, v[76:77]
    s_mov_b64 exec, s[94:95]
    v_and_b32 v56, 0x3ff, v31
    v_mul_u32_u24_sdwa v57, v42, v35 dst_sel:DWORD dst_unused:UNUSED_PAD src0_sel:DWORD src1_sel:BYTE_3
    v_add_u32 v56, v56, v57
    buffer_load_dwordx2 v[56:57], v56, s[40:43], 0 idxen
    s_setprio 0
    s_mov_b64 exec, s[92:93]
    v_lshrrev_b32 v60, 22, v30
    v_lshlrev_b32 v58, 2, v60
    v_lshlrev_b32 v60, 4, v60
    ds_add_rtn_u32 v58, v58, v3 offset:10000
    ds_read_b128 v[60:63], v60
    v_and_or_b32 v44, v30, s10, v40
    v_fmamk_f32 v44, v44, 0x3f800801, v41
    v_fma_f32 v46, v44, v44, -0.5
    v_cvt_pk_bf16_f32 v44, v44, v46
    s_mov_b64 exec, s[90:91]
    s_waitcnt vmcnt(2)
    v_mfma_f32_4x4x4_16b_bf16 v[72:75], v[96:97], v[52:53], 0 cbsz:4 abid:7
    s_waitcnt lgkmcnt(3)
    v_dot2_f32_bf16 v68, v64, v45, 0
    v_dot2_f32_bf16 v69, v65, v45, 0
    v_dot2_f32_bf16 v70, v66, v45, 0
    v_dot2_f32_bf16 v71, v67, v45, 0
    v_cmp_gt_i32 vcc, s54, v59
    s_nop 0
    v_pk_mul_f32 v[68:69], v[68:69], v[72:73]
    v_pk_mul_f32 v[70:71], v[70:71], v[74:75]
    s_cbranch_vccnz L2_p13_o
L2_p13_r:
    v_cvt_pk_bf16_f32 v76, v68, v69
    v_cvt_pk_bf16_f32 v77, v70, v71
    ds_write_b64 v59, v[76:77]
    s_mov_b64 exec, s[94:95]
    v_lshrrev_b32 v64, 22, v31
    v_lshlrev_b32 v59, 2, v64
    v_lshlrev_b32 v64, 4, v64
    ds_add_rtn_u32 v59, v59, v3 offset:10000
    ds_read_b128 v[64:67], v64
    v_and_or_b32 v45, v31, s10, v40
    v_fmamk_f32 v45, v45, 0x3f800801, v41
    v_fma_f32 v46, v45, v45, -0.5
    v_cvt_pk_bf16_f32 v45, v45, v46
    s_mov_b64 exec, s[92:93]
    s_waitcnt vmcnt(1)
    v_mfma_f32_4x4x4_16b_bf16 v[72:75], v[96:97], v[54:55], 0 cbsz:4 abid:7
    s_waitcnt lgkmcnt(3)
    v_dot2_f32_bf16 v68, v60, v44, 0
    v_dot2_f32_bf16 v69, v61, v44, 0
    v_dot2_f32_bf16 v70, v62, v44, 0
    v_dot2_f32_bf16 v71, v63, v44, 0
    v_cmp_gt_i32 vcc, s54, v58
    s_nop 0
    v_pk_mul_f32 v[68:69], v[68:69], v[72:73]
    v_pk_mul_f32 v[70:71], v[70:71], v[74:75]
    s_cbranch_vccnz L2_p14_o
L2_p14_r:
    v_cvt_pk_bf16_f32 v76, v68, v69
    v_cvt_pk_bf16_f32 v77, v70, v71
    ds_write_b64 v58, v[76:77]
    s_mov_b64 exec, s[94:95]
    s_waitcnt vmcnt(0)
    v_mfma_f32_4x4x4_16b_bf16 v[72:75], v[96:97], v[56:57], 0 cbsz:4 abid:7
    s_waitcnt lgkmcnt(1)
    v_dot2_f32_bf16 v68, v64, v45, 0
    v_dot2_f32_bf16 v69, v65, v45, 0
    v_dot2_f32_bf16 v70, v66, v45, 0
    v_dot2_f32_bf16 v71, v67, v45, 0
    v_cmp_gt_i32 vcc, s54, v59
    s_nop 0
    v_pk_mul_f32 v[68:69], v[68:69], v[72:73]
    v_pk_mul_f32 v[70:71], v[70:71], v[74:75]
    s_cbranch_vccnz L2_p15_o
L2_p15_r:
    v_cvt_pk_bf16_f32 v76, v68, v69
    v_cvt_pk_bf16_f32 v77, v70, v71
    ds_write_b64 v59, v[76:77]
L2_join:
    s_mov_b32 s28, s96
    s_and_b32 s29, s97, 0xffff
    s_mov_b32 s30, 1280000
    s_mov_b32 s31, 0x00020000
    s_cmp_lg_u32 s53, 0
    s_cbranch_scc1 L2_slow
L2_slow_r:
    s_mov_b64 exec, -1
    v_lshlrev_b32 v1, 3, v0
    v_add_u32 v2, 63792, v1
    v_add_u32 v3, 113792, v1
    v_lshlrev_b32 v108, 4, v0
    v_lshlrev_b32 v109, 3, v109
    s_waitcnt lgkmcnt(0)
    s_barrier
    s_cmp_ge_u32 s3, 10
    s_cbranch_scc1 L2_fin
    v_cmp_gt_u32 vcc, 625, v0
    s_mov_b64 exec, vcc
    ds_read_b128 v[72:75], v108 offset:12512
    ds_read_b64 v[16:17], v1 offset:23792
    ds_read_b64 v[18:19], v1 offset:28792
    ds_read_b64 v[20:21], v1 offset:33792
    ds_read_b64 v[22:23], v1 offset:38792
    ds_read_b64 v[24:25], v1 offset:43792
    ds_read_b64 v[26:27], v1 offset:48792
    ds_read_b64 v[28:29], v1 offset:53792
    ds_read_b64 v[30:31], v1 offset:58792
    ds_read_b64 v[32:33], v2 offset:0
    ds_read_b64 v[34:35], v2 offset:5000
    ds_read_b64 v[36:37], v2 offset:10000
    ds_read_b64 v[38:39], v2 offset:15000
    ds_read_b64 v[40:41], v2 offset:20000
    ds_read_b64 v[42:43], v2 offset:25000
    s_waitcnt lgkmcnt(14)
    v_cvt_pk_bf16_f32 v72, v72, v73
    v_cvt_pk_bf16_f32 v73, v74, v75
    ds_read_b64 v[44:45], v2 offset:30000
    s_waitcnt lgkmcnt(14)
    v_mfma_f32_4x4x4_16b_bf16 v[76:79], v[96:97], v[16:17], 0 cbsz:4 abid:6
    ds_read_b64 v[46:47], v2 offset:35000
    s_waitcnt lgkmcnt(14)
    v_mfma_f32_4x4x4_16b_bf16 v[80:83], v[96:97], v[18:19], 0 cbsz:4 abid:6
    ds_read_b64 v[48:49], v2 offset:40000
    s_waitcnt lgkmcnt(14)
    v_mfma_f32_4x4x4_16b_bf16 v[84:87], v[96:97], v[20:21], 0 cbsz:4 abid:6
    ds_read_b64 v[50:51], v2 offset:45000
    s_waitcnt lgkmcnt(14)
    v_mfma_f32_4x4x4_16b_bf16 v[76:79], v[96:97], v[22:23], v[76:79] cbsz:4 abid:6
    ds_read_b64 v[52:53], v3 offset:0
    s_waitcnt lgkmcnt(14)
    v_mfma_f32_4x4x4_16b_bf16 v[80:83], v[96:97], v[24:25], v[80:83] cbsz:4 abid:6
    ds_read_b64 v[54:55], v3 offset:5000
    s_waitcnt lgkmcnt(14)
    v_mfma_f32_4x4x4_16b_bf16 v[84:87], v[96:97], v[26:27], v[84:87] cbsz:4 abid:6
    ds_read_b64 v[56:57], v3 offset:10000
    s_waitcnt lgkmcnt(14)
    v_mfma_f32_4x4x4_16b_bf16 v[76:79], v[96:97], v[28:29], v[76:79] cbsz:4 abid:6
    ds_read_b64 v[58:59], v3 offset:15000
    s_waitcnt lgkmcnt(14)
    v_mfma_f32_4x4x4_16b_bf16 v[80:83], v[96:97], v[30:31], v[80:83] cbsz:4 abid:6
    ds_read_b64 v[60:61], v3 offset:20000
    s_waitcnt lgkmcnt(14)
    v_mfma_f32_4x4x4_16b_bf16 v[84:87], v[96:97], v[32:33], v[84:87] cbsz:4 abid:6
    ds_read_b64 v[62:63], v3 offset:25000
    s_waitcnt lgkmcnt(14)
    v_mfma_f32_4x4x4_16b_bf16 v[76:79], v[96:97], v[34:35], v[76:79] cbsz:4 abid:6
    ds_read_b64 v[64:65], v3 offset:30000
    s_waitcnt lgkmcnt(14)
    v_mfma_f32_4x4x4_16b_bf16 v[80:83], v[96:97], v[36:37], v[80:83] cbsz:4 abid:6
    ds_read_b64 v[66:67], v3 offset:35000
    s_waitcnt lgkmcnt(14)
    v_mfma_f32_4x4x4_16b_bf16 v[84:87], v[96:97], v[38:39], v[84:87] cbsz:4 abid:6
    ds_read_b64 v[68:69], v3 offset:40000
    s_waitcnt lgkmcnt(14)
    v_mfma_f32_4x4x4_16b_bf16 v[76:79], v[96:97], v[40:41], v[76:79] cbsz:4 abid:6
    ds_read_b64 v[70:71], v3 offset:45000
    s_waitcnt lgkmcnt(14)
    v_mfma_f32_4x4x4_16b_bf16 v[80:83], v[96:97], v[42:43], v[80:83] cbsz:4 abid:6
    s_waitcnt lgkmcnt(13)
    v_mfma_f32_4x4x4_16b_bf16 v[84:87], v[96:97], v[44:45], v[84:87] cbsz:4 abid:6
    s_waitcnt lgkmcnt(12)
    v_mfma_f32_4x4x4_16b_bf16 v[76:79], v[96:97], v[46:47], v[76:79] cbsz:4 abid:6
    s_waitcnt lgkmcnt(11)
    v_mfma_f32_4x4x4_16b_bf16 v[80:83], v[96:97], v[48:49], v[80:83] cbsz:4 abid:6
    s_waitcnt lgkmcnt(10)
    v_mfma_f32_4x4x4_16b_bf16 v[84:87], v[96:97], v[50:51], v[84:87] cbsz:4 abid:6
    s_waitcnt lgkmcnt(9)
    v_mfma_f32_4x4x4_16b_bf16 v[76:79], v[96:97], v[52:53], v[76:79] cbsz:4 abid:6
    s_waitcnt lgkmcnt(8)
    v_mfma_f32_4x4x4_16b_bf16 v[80:83], v[96:97], v[54:55], v[80:83] cbsz:4 abid:6
    s_waitcnt lgkmcnt(7)
    v_mfma_f32_4x4x4_16b_bf16 v[84:87], v[96:97], v[56:57], v[84:87] cbsz:4 abid:6
    s_waitcnt lgkmcnt(6)
    v_mfma_f32_4x4x4_16b_bf16 v[76:79], v[96:97], v[58:59], v[76:79] cbsz:4 abid:6
    s_waitcnt lgkmcnt(5)
    v_mfma_f32_4x4x4_16b_bf16 v[80:83], v[96:97], v[60:61], v[80:83] cbsz:4 abid:6
    s_waitcnt lgkmcnt(4)
    v_mfma_f32_4x4x4_16b_bf16 v[84:87], v[96:97], v[62:63], v[84:87] cbsz:4 abid:6
    s_waitcnt lgkmcnt(3)
    v_mfma_f32_4x4x4_16b_bf16 v[76:79], v[96:97], v[64:65], v[76:79] cbsz:4 abid:6
    s_waitcnt lgkmcnt(2)
    v_mfma_f32_4x4x4_16b_bf16 v[80:83], v[96:97], v[66:67], v[80:83] cbsz:4 abid:6
    s_waitcnt lgkmcnt(1)
    v_mfma_f32_4x4x4_16b_bf16 v[84:87], v[96:97], v[68:69], v[84:87] cbsz:4 abid:6
    s_waitcnt lgkmcnt(0)
    v_mfma_f32_4x4x4_16b_bf16 v[76:79], v[96:97], v[70:71], v[76:79] cbsz:4 abid:6
    v_mfma_f32_4x4x4_16b_bf16 v[80:83], v[96:97], v[72:73], v[80:83] cbsz:4 abid:6
    v_lshlrev_b32 v16, 16, v98
    v_and_b32 v17, 0xffff0000, v98
    v_lshlrev_b32 v18, 16, v99
    v_and_b32 v19, 0xffff0000, v99
    s_nop 1
    v_pk_add_f32 v[76:77], v[76:77], v[84:85]
    v_pk_add_f32 v[78:79], v[78:79], v[86:87]
    v_pk_add_f32 v[76:77], v[76:77], v[80:81]
    v_pk_add_f32 v[78:79], v[78:79], v[82:83]
    v_pk_fma_f32 v[16:17], v[76:77], v[100:101], v[16:17]
    v_pk_fma_f32 v[18:19], v[78:79], v[102:103], v[18:19]
    v_cvt_pk_bf16_f32 v16, v16, v17
    v_cvt_pk_bf16_f32 v17, v18, v19
    buffer_store_dwordx2 v[16:17], v109, s[28:31], 0 offen
L2_fin:
L_end:
    s_endpgm
L2_slow:
    s_add_u32 s14, s44, 262144
    s_mov_b64 exec, 0xffff
    buffer_load_dword v111, v12, s[36:39], s14 offen sc1
    s_waitcnt vmcnt(0) lgkmcnt(0)
L2_slow_seg:
    s_ff1_i32_b32 s13, s53
    v_readlane_b32 s14, v110, s13
    v_readlane_b32 s15, v111, s13
    s_bitset0_b32 s53, s13
    s_and_b32 s14, s14, 0xfffffc00
    s_min_u32 s15, s15, 10000
    s_sub_u32 s14, s14, 3072
    s_add_u32 s15, s15, 3
L2_slow_it:
    s_add_u32 s14, s14, 64512
    s_sub_u32 s15, s15, 63
    s_min_u32 s60, s15, 63
    s_or_b32 s52, s14, s60
    s_bfm_b64 exec, s52, 0
    s_lshr_b32 s60, s52, 10
    s_lshl_b32 s61, s60, 2
    buffer_load_dword v48, v1, s[32:35], s61 offen sc1
    buffer_load_ubyte v49, v2, s[4:7], s60 offen sc1
    s_waitcnt vmcnt(0)
    v_and_b32 v50, 0x3ff, v48
    v_mul_u32_u24_sdwa v51, v42, v49 dst_sel:DWORD dst_unused:UNUSED_PAD src0_sel:DWORD src1_sel:BYTE_0
    v_add_u32 v50, v50, v51
    buffer_load_dwordx2 v[50:51], v50, s[40:43], 0 idxen
    v_lshrrev_b32 v60, 22, v48
    v_lshlrev_b32 v58, 2, v60
    v_lshlrev_b32 v60, 4, v60
    ds_add_rtn_u32 v58, v58, v3 offset:10000
    ds_read_b128 v[60:63], v60
    v_and_or_b32 v44, v48, s10, v40
    v_fmamk_f32 v44, v44, 0x3f800801, v41
    v_fma_f32 v46, v44, v44, -0.5
    v_cvt_pk_bf16_f32 v44, v44, v46
    s_waitcnt vmcnt(0)
    v_mfma_f32_4x4x4_16b_bf16 v[72:75], v[96:97], v[50:51], 0 cbsz:4 abid:7
    s_waitcnt lgkmcnt(0)
    v_dot2_f32_bf16 v68, v60, v44, 0
    v_dot2_f32_bf16 v69, v61, v44, 0
    v_dot2_f32_bf16 v70, v62, v44, 0
    v_dot2_f32_bf16 v71, v63, v44, 0
    v_cmp_gt_i32 vcc, s54, v58
    s_nop 0
    v_pk_mul_f32 v[68:69], v[68:69], v[72:73]
    v_pk_mul_f32 v[70:71], v[70:71], v[74:75]
    s_cbranch_vccnz L2_ps_o
L2_ps_r:
    v_cvt_pk_bf16_f32 v76, v68, v69
    v_cvt_pk_bf16_f32 v77, v70, v71
    ds_write_b64 v58, v[76:77]
    s_waitcnt lgkmcnt(0)
    s_cmp_gt_i32 s15, 63
    s_cbranch_scc1 L2_slow_it
    s_cmp_lg_u32 s53, 0
    s_cbranch_scc1 L2_slow_seg
    s_branch L2_slow_r
L1_side:
    v_and_b32 v64, 63, v0
    v_subrev_u32 v65, 896, v0
    v_lshlrev_b32 v66, 4, v65
    ds_write_b128 v66, v[4:7] offset:33792
    s_cmp_eq_u32 s3, 14
    s_cbranch_scc1 L1_wt
    s_cmp_ge_u32 s2, 16
    s_cbranch_scc1 L1_nocl
    s_mul_i32 s14, s2, 16384
    s_add_u32 s14, s14, 16000000
    v_lshlrev_b32 v64, 4, v64
    s_waitcnt lgkmcnt(0)
    s_barrier
    s_add_u32 s16, s48, s14
    s_addc_u32 s17, s49, 0
    s_and_b32 s17, s17, 0xffff
    s_mov_b32 s18, 16384
    s_mov_b32 s19, 0x00020000
    s_mov_b32 s14, 0
    buffer_store_dwordx4 v[4:7], v64, s[16:19], s14 offen offset:0 sc1
    buffer_store_dwordx4 v[4:7], v64, s[16:19], s14 offen offset:1024 sc1
    buffer_store_dwordx4 v[4:7], v64, s[16:19], s14 offen offset:2048 sc1
    buffer_store_dwordx4 v[4:7], v64, s[16:19], s14 offen offset:3072 sc1
    s_mov_b32 s14, 4096
    buffer_store_dwordx4 v[4:7], v64, s[16:19], s14 offen offset:0 sc1
    buffer_store_dwordx4 v[4:7], v64, s[16:19], s14 offen offset:1024 sc1
    buffer_store_dwordx4 v[4:7], v64, s[16:19], s14 offen offset:2048 sc1
    buffer_store_dwordx4 v[4:7], v64, s[16:19], s14 offen offset:3072 sc1
    s_mov_b32 s14, 8192
    buffer_store_dwordx4 v[4:7], v64, s[16:19], s14 offen offset:0 sc1
    buffer_store_dwordx4 v[4:7], v64, s[16:19], s14 offen offset:1024 sc1
    buffer_store_dwordx4 v[4:7], v64, s[16:19], s14 offen offset:2048 sc1
    buffer_store_dwordx4 v[4:7], v64, s[16:19], s14 offen offset:3072 sc1
    s_mov_b32 s14, 12288
    buffer_store_dwordx4 v[4:7], v64, s[16:19], s14 offen offset:0 sc1
    buffer_store_dwordx4 v[4:7], v64, s[16:19], s14 offen offset:1024 sc1
    buffer_store_dwordx4 v[4:7], v64, s[16:19], s14 offen offset:2048 sc1
    buffer_store_dwordx4 v[4:7], v64, s[16:19], s14 offen offset:3072 sc1
    s_branch L1_side2
L1_nocl:
    s_waitcnt lgkmcnt(0)
    s_barrier
    s_branch L1_side2
L1_wt:
    s_load_dwordx8 s[60:67], s[0:1], 56
    s_waitcnt lgkmcnt(0)
    v_and_b32 v8, 3, v64
    v_lshlrev_b32 v8, 1, v8
    v_bfe_u32 v11, v64, 2, 1
    v_lshl_add_u32 v9, v11, 6, v8
    v_lshl_add_u32 v10, v11, 5, v8
    v_bfe_u32 v11, v64, 3, 1
    v_lshl_add_u32 v9, v11, 3, v9
    v_mov_b64 v[12:13], 0
    v_mov_b64 v[14:15], 0
    s_mov_b32 s16, s62
    s_and_b32 s17, s63, 0xffff
    s_mov_b32 s18, 128
    s_mov_b32 s19, 0x00020000
    s_mov_b32 exec_lo, 0xffff
    s_mov_b32 exec_hi, 0
    buffer_load_ushort v12, v9, s[16:19], 0 offen offset:0
    buffer_load_ushort v14, v9, s[16:19], 0 offen offset:16
    buffer_load_ushort v13, v9, s[16:19], 0 offen offset:32
    buffer_load_ushort v15, v9, s[16:19], 0 offen offset:48
    s_mov_b32 s16, s60
    s_and_b32 s17, s61, 0xffff
    s_mov_b32 s18, 64
    s_mov_b32 s19, 0x00020000
    s_mov_b32 exec_lo, 0xff0000
    s_mov_b32 exec_hi, 0
    buffer_load_ushort v12, v10, s[16:19], 0 offen offset:0
    buffer_load_ushort v14, v10, s[16:19], 0 offen offset:8
    buffer_load_ushort v13, v10, s[16:19], 0 offen offset:16
    buffer_load_ushort v15, v10, s[16:19], 0 offen offset:24
    s_mov_b32 s16, s66
    s_and_b32 s17, s67, 0xffff
    s_mov_b32 s18, 32
    s_mov_b32 s19, 0x00020000
    s_mov_b32 exec_lo, 0xf000000
    s_mov_b32 exec_hi, 0
    buffer_load_ushort v12, v8, s[16:19], 0 offen offset:0
    buffer_load_ushort v14, v8, s[16:19], 0 offen offset:8
    buffer_load_ushort v13, v8, s[16:19], 0 offen offset:16
    buffer_load_ushort v15, v8, s[16:19], 0 offen offset:24
    s_mov_b32 s16, s64
    s_and_b32 s17, s65, 0xffff
    s_mov_b32 s18, 32
    s_mov_b32 s19, 0x00020000
    s_mov_b32 exec_lo, 0xf0000000
    s_mov_b32 exec_hi, 0
    buffer_load_ushort v12, v8, s[16:19], 0 offen offset:0
    buffer_load_ushort v14, v8, s[16:19], 0 offen offset:8
    buffer_load_ushort v13, v8, s[16:19], 0 offen offset:16
    buffer_load_ushort v15, v8, s[16:19], 0 offen offset:24
    s_mov_b64 exec, -1
    s_barrier
    v_lshlrev_b32 v64, 3, v64
    v_add_u32 v64, 23536, v64
L1_side2:
    ds_write_b128 v66, v[4:7] offset:12512
    ds_write_b128 v66, v[4:7] offset:14560
    ds_write_b128 v66, v[4:7] offset:16608
    ds_write_b128 v66, v[4:7] offset:18656
    ds_write_b128 v66, v[4:7] offset:20464
    v_add_u32 v72, 90352, v66
    s_waitcnt lgkmcnt(4)
    ds_write_b128 v72, v[4:7] offset:0
    ds_write_b128 v72, v[4:7] offset:2048
    ds_write_b128 v72, v[4:7] offset:4096
    ds_write_b128 v72, v[4:7] offset:6144
    ds_write_b128 v72, v[4:7] offset:8192
    ds_write_b128 v72, v[4:7] offset:10240
    ds_write_b128 v72, v[4:7] offset:12288
    ds_write_b128 v72, v[4:7] offset:14336
    s_waitcnt lgkmcnt(4)
    ds_write_b128 v72, v[4:7] offset:16384
    ds_write_b128 v72, v[4:7] offset:18432
    ds_write_b128 v72, v[4:7] offset:20480
    ds_write_b128 v72, v[4:7] offset:22528
    ds_write_b128 v72, v[4:7] offset:24576
    ds_write_b128 v72, v[4:7] offset:26624
    ds_write_b128 v72, v[4:7] offset:28672
    ds_write_b128 v72, v[4:7] offset:30720
    s_waitcnt lgkmcnt(4)
    ds_write_b128 v72, v[4:7] offset:32768
    ds_write_b128 v72, v[4:7] offset:34816
    ds_write_b128 v72, v[4:7] offset:36864
    ds_write_b128 v72, v[4:7] offset:38912
    ds_write_b128 v72, v[4:7] offset:40960
    ds_write_b128 v72, v[4:7] offset:43008
    ds_write_b128 v72, v[4:7] offset:45056
    ds_write_b128 v72, v[4:7] offset:47104
    s_waitcnt lgkmcnt(4)
    ds_write_b128 v72, v[4:7] offset:49152
    ds_write_b128 v72, v[4:7] offset:51200
    ds_write_b128 v72, v[4:7] offset:53248
    ds_write_b128 v72, v[4:7] offset:55296
    ds_write_b128 v72, v[4:7] offset:57344
    ds_write_b128 v72, v[4:7] offset:59392
    ds_write_b128 v72, v[4:7] offset:61440
    v_add_u32 v72, 153840, v66
    s_waitcnt lgkmcnt(4)
    ds_write_b128 v72, v[4:7] offset:0
    ds_write_b128 v72, v[4:7] offset:2048
    ds_write_b128 v72, v[4:7] offset:4096
    ds_write_b128 v72, v[4:7] offset:6144
    ds_write_b128 v72, v[4:7] offset:7904
    v_lshlrev_b32 v68, 3, v65
    v_add_u32 v70, 23792, v68
    v_add_u32 v71, 4, v70
    ds_write_b64 v68, v[70:71] offset:22512
    s_mul_i32 s45, s2, 10240
    s_add_u32 s45, s45, 64
    s_lshl_b32 s12, s45, 2
    s_add_u32 s12, s12, 0
    s_add_u32 s13, s45, 10489856
    s_add_u32 s28, s48, s12
    s_addc_u32 s29, s49, 0
    s_and_b32 s29, s29, 0xffff
    s_mov_b32 s30, 40000
    s_mov_b32 s31, 0x00020000
    s_add_u32 s32, s48, s13
    s_addc_u32 s33, s49, 0
    s_and_b32 s33, s33, 0xffff
    s_mov_b32 s34, 10000
    s_mov_b32 s35, 0x00020000
    s_add_u32 s36, s48, 16000000
    s_addc_u32 s37, s49, 0
    s_and_b32 s37, s37, 0xffff
    s_mov_b32 s38, 524288
    s_mov_b32 s39, 0x00020000
    s_add_u32 s40, s50, 0
    s_addc_u32 s41, s51, 0
    s_and_b32 s41, s41, 0xffff
    s_or_b32 s41, s41, 524288
    s_mov_b32 s42, 160000
    s_mov_b32 s43, 0x00020000
    s_mul_i32 s14, s56, 128
    s_add_u32 s15, s14, 262144
    v_add_u32 v62, 16384, v1
    v_add_u32 v63, 32768, v1
    s_waitcnt lgkmcnt(0)
    s_barrier
    s_cmp_lg_u32 s3, 14
    s_cbranch_scc1 L1_w15
    s_waitcnt vmcnt(0)
    v_lshl_or_b32 v12, v14, 16, v12
    v_lshl_or_b32 v13, v15, 16, v13
    s_mov_b32 exec_hi, 0
    ds_write_b64 v64, v[12:13]
    s_mov_b32 exec_hi, -1
    s_waitcnt lgkmcnt(0)
L1_side3:
    s_branch L1_cpa
L1_w15:
    s_cmp_ge_u32 s2, 16
    s_cbranch_scc1 L1_cpa
    s_mov_b32 s20, s98
    s_and_b32 s21, s99, 0xffff
    s_mov_b32 s22, 256
    s_mov_b32 s23, 0x00020000
    s_mul_i32 s8, s2, 16
    v_mov_b32 v69, s8
    v_mov_b32 v67, 1
    s_mov_b64 exec, 1
    s_waitcnt vmcnt(0)
    buffer_store_dword v67, v69, s[20:23], 0 offen sc1
    s_mov_b64 exec, -1
    s_branch L1_cpa
L1_fl:
    s_cmp_lg_u32 s3, 15
    s_cbranch_scc1 L2_noag
    s_mov_b32 s24, s98
    s_and_b32 s25, s99, 0xffff
    s_mov_b32 s26, 256
    s_mov_b32 s27, 0x00020000
    v_and_b32 v64, 15, v0
    v_mul_u32_u24 v64, 16, v64
    s_mov_b32 s8, 0
L1_fspin:
    buffer_load_dword v111, v64, s[24:27], 0 offen sc1
    s_add_u32 s8, s8, 1
    s_cmp_gt_u32 s8, 300000
    s_waitcnt vmcnt(0)
    s_cbranch_scc1 L2_noag
    v_cmp_eq_u32 vcc, 0, v111
    s_cbranch_vccnz L1_fspin
    s_branch L2_noag
L2_repoll:
    s_add_u32 s45, s45, 1
    s_cmp_gt_u32 s45, 300000
    s_cbranch_scc1 L2_sorted
    s_andn2_b32 exec_lo, 0xffff, s25
    s_mov_b32 exec_hi, 0
    buffer_load_dword v110, v12, s[36:39], s44 offen sc1
    s_waitcnt vmcnt(0)
    s_branch L2_round
L2_x0:
    s_mov_b64 s[62:63], exec
L2_x0_l:
    s_ff1_i32_b64 s13, vcc
    v_readlane_b32 s14, v93, s13
    s_bfm_b64 s[60:61], 16, s13
    s_andn2_b64 vcc, vcc, s[60:61]
    s_and_b32 s60, s14, 0x3ff
    s_cmp_gt_u32 s60, 123
    s_cbranch_scc1 L2_x0_s
    s_cmp_lg_u32 s52, 0
    s_cbranch_scc1 L2_x0_s
    s_add_u32 s52, s14, 61380
    s_bfm_b64 exec, s52, 0
    s_lshr_b32 s60, s52, 10
    s_lshl_b32 s61, s60, 2
    buffer_load_dword v48, v1, s[32:35], s61 offen sc1
    buffer_load_ubyte v49, v2, s[4:7], s60 offen sc1
    s_branch L2_x0_n
L2_x0_s:
    s_mov_b64 exec, 0xffff
    s_nop 3
    v_cmp_eq_u32 s[60:61], s14, v110
    s_or_b32 s53, s53, s60
L2_x0_n:
    s_cmp_lg_u64 vcc, 0
    s_cbranch_scc1 L2_x0_l
    s_mov_b64 exec, s[62:63]
    s_branch L2_x0_r
L2_x1:
    s_mov_b64 s[62:63], exec
L2_x1_l:
    s_ff1_i32_b64 s13, vcc
    v_readlane_b32 s14, v93, s13
    s_bfm_b64 s[60:61], 16, s13
    s_andn2_b64 vcc, vcc, s[60:61]
    s_and_b32 s60, s14, 0x3ff
    s_cmp_gt_u32 s60, 123
    s_cbranch_scc1 L2_x1_s
    s_cmp_lg_u32 s52, 0
    s_cbranch_scc1 L2_x1_s
    s_add_u32 s52, s14, 61380
    s_bfm_b64 exec, s52, 0
    s_lshr_b32 s60, s52, 10
    s_lshl_b32 s61, s60, 2
    buffer_load_dword v48, v1, s[32:35], s61 offen sc1
    buffer_load_ubyte v49, v2, s[4:7], s60 offen sc1
    s_branch L2_x1_n
L2_x1_s:
    s_mov_b64 exec, 0xffff
    s_nop 3
    v_cmp_eq_u32 s[60:61], s14, v110
    s_or_b32 s53, s53, s60
L2_x1_n:
    s_cmp_lg_u64 vcc, 0
    s_cbranch_scc1 L2_x1_l
    s_mov_b64 exec, s[62:63]
    s_branch L2_x1_r
L2_x2:
    s_mov_b64 s[62:63], exec
L2_x2_l:
    s_ff1_i32_b64 s13, vcc
    v_readlane_b32 s14, v93, s13
    s_bfm_b64 s[60:61], 16, s13
    s_andn2_b64 vcc, vcc, s[60:61]
    s_and_b32 s60, s14, 0x3ff
    s_cmp_gt_u32 s60, 123
    s_cbranch_scc1 L2_x2_s
    s_cmp_lg_u32 s52, 0
    s_cbranch_scc1 L2_x2_s
    s_add_u32 s52, s14, 61380
    s_bfm_b64 exec, s52, 0
    s_lshr_b32 s60, s52, 10
    s_lshl_b32 s61, s60, 2
    buffer_load_dword v48, v1, s[32:35], s61 offen sc1
    buffer_load_ubyte v49, v2, s[4:7], s60 offen sc1
    s_branch L2_x2_n
L2_x2_s:
    s_mov_b64 exec, 0xffff
    s_nop 3
    v_cmp_eq_u32 s[60:61], s14, v110
    s_or_b32 s53, s53, s60
L2_x2_n:
    s_cmp_lg_u64 vcc, 0
    s_cbranch_scc1 L2_x2_l
    s_mov_b64 exec, s[62:63]
    s_branch L2_x2_r
L2_x3:
    s_mov_b64 s[62:63], exec
L2_x3_l:
    s_ff1_i32_b64 s13, vcc
    v_readlane_b32 s14, v93, s13
    s_bfm_b64 s[60:61], 16, s13
    s_andn2_b64 vcc, vcc, s[60:61]
    s_and_b32 s60, s14, 0x3ff
    s_cmp_gt_u32 s60, 123
    s_cbranch_scc1 L2_x3_s
    s_cmp_lg_u32 s52, 0
    s_cbranch_scc1 L2_x3_s
    s_add_u32 s52, s14, 61380
    s_bfm_b64 exec, s52, 0
    s_lshr_b32 s60, s52, 10
    s_lshl_b32 s61, s60, 2
    buffer_load_dword v48, v1, s[32:35], s61 offen sc1
    buffer_load_ubyte v49, v2, s[4:7], s60 offen sc1
    s_branch L2_x3_n
L2_x3_s:
    s_mov_b64 exec, 0xffff
    s_nop 3
    v_cmp_eq_u32 s[60:61], s14, v110
    s_or_b32 s53, s53, s60
L2_x3_n:
    s_cmp_lg_u64 vcc, 0
    s_cbranch_scc1 L2_x3_l
    s_mov_b64 exec, s[62:63]
    s_branch L2_x3_r
L2_s0_o:
    s_mov_b64 s[62:63], exec
    s_mov_b64 s[60:61], vcc
    s_mov_b64 exec, vcc
    v_bfe_u32 v77, v32, 0, 8
    v_lshl_or_b32 v78, v2, 1, 1
L2_s0_l:
    v_lshlrev_b32 v68, 2, v77
    ds_sub_u32 v68, v14 offset:22512
    v_add_u32 v77, v77, v78
    v_and_b32 v77, 0xff, v77
    v_lshlrev_b32 v68, 2, v77
    ds_add_rtn_u32 v68, v68, v14 offset:22512
    s_waitcnt lgkmcnt(0)
    v_cmp_le_u32 vcc, s57, v68
    s_mov_b64 exec, vcc
    s_cbranch_vccnz L2_s0_l
    s_mov_b64 exec, s[60:61]
    v_bfe_u32 v78, v32, 0, 8
    v_xor_b32 v77, v77, v78
    v_lshrrev_b32 v78, 2, v68
    v_add_u32 v78, 84404, v78
    ds_write_b8 v78, v77
    s_waitcnt lgkmcnt(0)
    s_mov_b64 exec, s[62:63]
    s_branch L2_s0_r
L2_s1_o:
    s_mov_b64 s[62:63], exec
    s_mov_b64 s[60:61], vcc
    s_mov_b64 exec, vcc
    v_bfe_u32 v77, v32, 8, 8
    v_lshl_or_b32 v78, v2, 1, 1
L2_s1_l:
    v_lshlrev_b32 v69, 2, v77
    ds_sub_u32 v69, v14 offset:22512
    v_add_u32 v77, v77, v78
    v_and_b32 v77, 0xff, v77
    v_lshlrev_b32 v69, 2, v77
    ds_add_rtn_u32 v69, v69, v14 offset:22512
    s_waitcnt lgkmcnt(0)
    v_cmp_le_u32 vcc, s57, v69
    s_mov_b64 exec, vcc
    s_cbranch_vccnz L2_s1_l
    s_mov_b64 exec, s[60:61]
    v_bfe_u32 v78, v32, 8, 8
    v_xor_b32 v77, v77, v78
    v_lshrrev_b32 v78, 2, v69
    v_add_u32 v78, 84404, v78
    ds_write_b8 v78, v77
    s_waitcnt lgkmcnt(0)
    s_mov_b64 exec, s[62:63]
    s_branch L2_s1_r
L2_s2_o:
    s_mov_b64 s[62:63], exec
    s_mov_b64 s[60:61], vcc
    s_mov_b64 exec, vcc
    v_bfe_u32 v77, v32, 16, 8
    v_lshl_or_b32 v78, v2, 1, 1
L2_s2_l:
    v_lshlrev_b32 v70, 2, v77
    ds_sub_u32 v70, v14 offset:22512
    v_add_u32 v77, v77, v78
    v_and_b32 v77, 0xff, v77
    v_lshlrev_b32 v70, 2, v77
    ds_add_rtn_u32 v70, v70, v14 offset:22512
    s_waitcnt lgkmcnt(0)
    v_cmp_le_u32 vcc, s57, v70
    s_mov_b64 exec, vcc
    s_cbranch_vccnz L2_s2_l
    s_mov_b64 exec, s[60:61]
    v_bfe_u32 v78, v32, 16, 8
    v_xor_b32 v77, v77, v78
    v_lshrrev_b32 v78, 2, v70
    v_add_u32 v78, 84404, v78
    ds_write_b8 v78, v77
    s_waitcnt lgkmcnt(0)
    s_mov_b64 exec, s[62:63]
    s_branch L2_s2_r
L2_s3_o:
    s_mov_b64 s[62:63], exec
    s_mov_b64 s[60:61], vcc
    s_mov_b64 exec, vcc
    v_bfe_u32 v77, v32, 24, 8
    v_lshl_or_b32 v78, v2, 1, 1
L2_s3_l:
    v_lshlrev_b32 v71, 2, v77
    ds_sub_u32 v71, v14 offset:22512
    v_add_u32 v77, v77, v78
    v_and_b32 v77, 0xff, v77
    v_lshlrev_b32 v71, 2, v77
    ds_add_rtn_u32 v71, v71, v14 offset:22512
    s_waitcnt lgkmcnt(0)
    v_cmp_le_u32 vcc, s57, v71
    s_mov_b64 exec, vcc
    s_cbranch_vccnz L2_s3_l
    s_mov_b64 exec, s[60:61]
    v_bfe_u32 v78, v32, 24, 8
    v_xor_b32 v77, v77, v78
    v_lshrrev_b32 v78, 2, v71
    v_add_u32 v78, 84404, v78
    ds_write_b8 v78, v77
    s_waitcnt lgkmcnt(0)
    s_mov_b64 exec, s[62:63]
    s_branch L2_s3_r
L2_s4_o:
    s_mov_b64 s[62:63], exec
    s_mov_b64 s[60:61], vcc
    s_mov_b64 exec, vcc
    v_bfe_u32 v77, v33, 0, 8
    v_lshl_or_b32 v78, v2, 1, 1
L2_s4_l:
    v_lshlrev_b32 v68, 2, v77
    ds_sub_u32 v68, v14 offset:22512
    v_add_u32 v77, v77, v78
    v_and_b32 v77, 0xff, v77
    v_lshlrev_b32 v68, 2, v77
    ds_add_rtn_u32 v68, v68, v14 offset:22512
    s_waitcnt lgkmcnt(0)
    v_cmp_le_u32 vcc, s57, v68
    s_mov_b64 exec, vcc
    s_cbranch_vccnz L2_s4_l
    s_mov_b64 exec, s[60:61]
    v_bfe_u32 v78, v33, 0, 8
    v_xor_b32 v77, v77, v78
    v_lshrrev_b32 v78, 2, v68
    v_add_u32 v78, 84404, v78
    ds_write_b8 v78, v77
    s_waitcnt lgkmcnt(0)
    s_mov_b64 exec, s[62:63]
    s_branch L2_s4_r
L2_s5_o:
    s_mov_b64 s[62:63], exec
    s_mov_b64 s[60:61], vcc
    s_mov_b64 exec, vcc
    v_bfe_u32 v77, v33, 8, 8
    v_lshl_or_b32 v78, v2, 1, 1
L2_s5_l:
    v_lshlrev_b32 v69, 2, v77
    ds_sub_u32 v69, v14 offset:22512
    v_add_u32 v77, v77, v78
    v_and_b32 v77, 0xff, v77
    v_lshlrev_b32 v69, 2, v77
    ds_add_rtn_u32 v69, v69, v14 offset:22512
    s_waitcnt lgkmcnt(0)
    v_cmp_le_u32 vcc, s57, v69
    s_mov_b64 exec, vcc
    s_cbranch_vccnz L2_s5_l
    s_mov_b64 exec, s[60:61]
    v_bfe_u32 v78, v33, 8, 8
    v_xor_b32 v77, v77, v78
    v_lshrrev_b32 v78, 2, v69
    v_add_u32 v78, 84404, v78
    ds_write_b8 v78, v77
    s_waitcnt lgkmcnt(0)
    s_mov_b64 exec, s[62:63]
    s_branch L2_s5_r
L2_s6_o:
    s_mov_b64 s[62:63], exec
    s_mov_b64 s[60:61], vcc
    s_mov_b64 exec, vcc
    v_bfe_u32 v77, v33, 16, 8
    v_lshl_or_b32 v78, v2, 1, 1
L2_s6_l:
    v_lshlrev_b32 v70, 2, v77
    ds_sub_u32 v70, v14 offset:22512
    v_add_u32 v77, v77, v78
    v_and_b32 v77, 0xff, v77
    v_lshlrev_b32 v70, 2, v77
    ds_add_rtn_u32 v70, v70, v14 offset:22512
    s_waitcnt lgkmcnt(0)
    v_cmp_le_u32 vcc, s57, v70
    s_mov_b64 exec, vcc
    s_cbranch_vccnz L2_s6_l
    s_mov_b64 exec, s[60:61]
    v_bfe_u32 v78, v33, 16, 8
    v_xor_b32 v77, v77, v78
    v_lshrrev_b32 v78, 2, v70
    v_add_u32 v78, 84404, v78
    ds_write_b8 v78, v77
    s_waitcnt lgkmcnt(0)
    s_mov_b64 exec, s[62:63]
    s_branch L2_s6_r
L2_s7_o:
    s_mov_b64 s[62:63], exec
    s_mov_b64 s[60:61], vcc
    s_mov_b64 exec, vcc
    v_bfe_u32 v77, v33, 24, 8
    v_lshl_or_b32 v78, v2, 1, 1
L2_s7_l:
    v_lshlrev_b32 v71, 2, v77
    ds_sub_u32 v71, v14 offset:22512
    v_add_u32 v77, v77, v78
    v_and_b32 v77, 0xff, v77
    v_lshlrev_b32 v71, 2, v77
    ds_add_rtn_u32 v71, v71, v14 offset:22512
    s_waitcnt lgkmcnt(0)
    v_cmp_le_u32 vcc, s57, v71
    s_mov_b64 exec, vcc
    s_cbranch_vccnz L2_s7_l
    s_mov_b64 exec, s[60:61]
    v_bfe_u32 v78, v33, 24, 8
    v_xor_b32 v77, v77, v78
    v_lshrrev_b32 v78, 2, v71
    v_add_u32 v78, 84404, v78
    ds_write_b8 v78, v77
    s_waitcnt lgkmcnt(0)
    s_mov_b64 exec, s[62:63]
    s_branch L2_s7_r
L2_s8_o:
    s_mov_b64 s[62:63], exec
    s_mov_b64 s[60:61], vcc
    s_mov_b64 exec, vcc
    v_bfe_u32 v77, v34, 0, 8
    v_lshl_or_b32 v78, v2, 1, 1
L2_s8_l:
    v_lshlrev_b32 v68, 2, v77
    ds_sub_u32 v68, v14 offset:22512
    v_add_u32 v77, v77, v78
    v_and_b32 v77, 0xff, v77
    v_lshlrev_b32 v68, 2, v77
    ds_add_rtn_u32 v68, v68, v14 offset:22512
    s_waitcnt lgkmcnt(0)
    v_cmp_le_u32 vcc, s57, v68
    s_mov_b64 exec, vcc
    s_cbranch_vccnz L2_s8_l
    s_mov_b64 exec, s[60:61]
    v_bfe_u32 v78, v34, 0, 8
    v_xor_b32 v77, v77, v78
    v_lshrrev_b32 v78, 2, v68
    v_add_u32 v78, 84404, v78
    ds_write_b8 v78, v77
    s_waitcnt lgkmcnt(0)
    s_mov_b64 exec, s[62:63]
    s_branch L2_s8_r
L2_s9_o:
    s_mov_b64 s[62:63], exec
    s_mov_b64 s[60:61], vcc
    s_mov_b64 exec, vcc
    v_bfe_u32 v77, v34, 8, 8
    v_lshl_or_b32 v78, v2, 1, 1
L2_s9_l:
    v_lshlrev_b32 v69, 2, v77
    ds_sub_u32 v69, v14 offset:22512
    v_add_u32 v77, v77, v78
    v_and_b32 v77, 0xff, v77
    v_lshlrev_b32 v69, 2, v77
    ds_add_rtn_u32 v69, v69, v14 offset:22512
    s_waitcnt lgkmcnt(0)
    v_cmp_le_u32 vcc, s57, v69
    s_mov_b64 exec, vcc
    s_cbranch_vccnz L2_s9_l
    s_mov_b64 exec, s[60:61]
    v_bfe_u32 v78, v34, 8, 8
    v_xor_b32 v77, v77, v78
    v_lshrrev_b32 v78, 2, v69
    v_add_u32 v78, 84404, v78
    ds_write_b8 v78, v77
    s_waitcnt lgkmcnt(0)
    s_mov_b64 exec, s[62:63]
    s_branch L2_s9_r
L2_s10_o:
    s_mov_b64 s[62:63], exec
    s_mov_b64 s[60:61], vcc
    s_mov_b64 exec, vcc
    v_bfe_u32 v77, v34, 16, 8
    v_lshl_or_b32 v78, v2, 1, 1
L2_s10_l:
    v_lshlrev_b32 v70, 2, v77
    ds_sub_u32 v70, v14 offset:22512
    v_add_u32 v77, v77, v78
    v_and_b32 v77, 0xff, v77
    v_lshlrev_b32 v70, 2, v77
    ds_add_rtn_u32 v70, v70, v14 offset:22512
    s_waitcnt lgkmcnt(0)
    v_cmp_le_u32 vcc, s57, v70
    s_mov_b64 exec, vcc
    s_cbranch_vccnz L2_s10_l
    s_mov_b64 exec, s[60:61]
    v_bfe_u32 v78, v34, 16, 8
    v_xor_b32 v77, v77, v78
    v_lshrrev_b32 v78, 2, v70
    v_add_u32 v78, 84404, v78
    ds_write_b8 v78, v77
    s_waitcnt lgkmcnt(0)
    s_mov_b64 exec, s[62:63]
    s_branch L2_s10_r
L2_s11_o:
    s_mov_b64 s[62:63], exec
    s_mov_b64 s[60:61], vcc
    s_mov_b64 exec, vcc
    v_bfe_u32 v77, v34, 24, 8
    v_lshl_or_b32 v78, v2, 1, 1
L2_s11_l:
    v_lshlrev_b32 v71, 2, v77
    ds_sub_u32 v71, v14 offset:22512
    v_add_u32 v77, v77, v78
    v_and_b32 v77, 0xff, v77
    v_lshlrev_b32 v71, 2, v77
    ds_add_rtn_u32 v71, v71, v14 offset:22512
    s_waitcnt lgkmcnt(0)
    v_cmp_le_u32 vcc, s57, v71
    s_mov_b64 exec, vcc
    s_cbranch_vccnz L2_s11_l
    s_mov_b64 exec, s[60:61]
    v_bfe_u32 v78, v34, 24, 8
    v_xor_b32 v77, v77, v78
    v_lshrrev_b32 v78, 2, v71
    v_add_u32 v78, 84404, v78
    ds_write_b8 v78, v77
    s_waitcnt lgkmcnt(0)
    s_mov_b64 exec, s[62:63]
    s_branch L2_s11_r
L2_s12_o:
    s_mov_b64 s[62:63], exec
    s_mov_b64 s[60:61], vcc
    s_mov_b64 exec, vcc
    v_bfe_u32 v77, v35, 0, 8
    v_lshl_or_b32 v78, v2, 1, 1
L2_s12_l:
    v_lshlrev_b32 v68, 2, v77
    ds_sub_u32 v68, v14 offset:22512
    v_add_u32 v77, v77, v78
    v_and_b32 v77, 0xff, v77
    v_lshlrev_b32 v68, 2, v77
    ds_add_rtn_u32 v68, v68, v14 offset:22512
    s_waitcnt lgkmcnt(0)
    v_cmp_le_u32 vcc, s57, v68
    s_mov_b64 exec, vcc
    s_cbranch_vccnz L2_s12_l
    s_mov_b64 exec, s[60:61]
    v_bfe_u32 v78, v35, 0, 8
    v_xor_b32 v77, v77, v78
    v_lshrrev_b32 v78, 2, v68
    v_add_u32 v78, 84404, v78
    ds_write_b8 v78, v77
    s_waitcnt lgkmcnt(0)
    s_mov_b64 exec, s[62:63]
    s_branch L2_s12_r
L2_s13_o:
    s_mov_b64 s[62:63], exec
    s_mov_b64 s[60:61], vcc
    s_mov_b64 exec, vcc
    v_bfe_u32 v77, v35, 8, 8
    v_lshl_or_b32 v78, v2, 1, 1
L2_s13_l:
    v_lshlrev_b32 v69, 2, v77
    ds_sub_u32 v69, v14 offset:22512
    v_add_u32 v77, v77, v78
    v_and_b32 v77, 0xff, v77
    v_lshlrev_b32 v69, 2, v77
    ds_add_rtn_u32 v69, v69, v14 offset:22512
    s_waitcnt lgkmcnt(0)
    v_cmp_le_u32 vcc, s57, v69
    s_mov_b64 exec, vcc
    s_cbranch_vccnz L2_s13_l
    s_mov_b64 exec, s[60:61]
    v_bfe_u32 v78, v35, 8, 8
    v_xor_b32 v77, v77, v78
    v_lshrrev_b32 v78, 2, v69
    v_add_u32 v78, 84404, v78
    ds_write_b8 v78, v77
    s_waitcnt lgkmcnt(0)
    s_mov_b64 exec, s[62:63]
    s_branch L2_s13_r
L2_s14_o:
    s_mov_b64 s[62:63], exec
    s_mov_b64 s[60:61], vcc
    s_mov_b64 exec, vcc
    v_bfe_u32 v77, v35, 16, 8
    v_lshl_or_b32 v78, v2, 1, 1
L2_s14_l:
    v_lshlrev_b32 v70, 2, v77
    ds_sub_u32 v70, v14 offset:22512
    v_add_u32 v77, v77, v78
    v_and_b32 v77, 0xff, v77
    v_lshlrev_b32 v70, 2, v77
    ds_add_rtn_u32 v70, v70, v14 offset:22512
    s_waitcnt lgkmcnt(0)
    v_cmp_le_u32 vcc, s57, v70
    s_mov_b64 exec, vcc
    s_cbranch_vccnz L2_s14_l
    s_mov_b64 exec, s[60:61]
    v_bfe_u32 v78, v35, 16, 8
    v_xor_b32 v77, v77, v78
    v_lshrrev_b32 v78, 2, v70
    v_add_u32 v78, 84404, v78
    ds_write_b8 v78, v77
    s_waitcnt lgkmcnt(0)
    s_mov_b64 exec, s[62:63]
    s_branch L2_s14_r
L2_s15_o:
    s_mov_b64 s[62:63], exec
    s_mov_b64 s[60:61], vcc
    s_mov_b64 exec, vcc
    v_bfe_u32 v77, v35, 24, 8
    v_lshl_or_b32 v78, v2, 1, 1
L2_s15_l:
    v_lshlrev_b32 v71, 2, v77
    ds_sub_u32 v71, v14 offset:22512
    v_add_u32 v77, v77, v78
    v_and_b32 v77, 0xff, v77
    v_lshlrev_b32 v71, 2, v77
    ds_add_rtn_u32 v71, v71, v14 offset:22512
    s_waitcnt lgkmcnt(0)
    v_cmp_le_u32 vcc, s57, v71
    s_mov_b64 exec, vcc
    s_cbranch_vccnz L2_s15_l
    s_mov_b64 exec, s[60:61]
    v_bfe_u32 v78, v35, 24, 8
    v_xor_b32 v77, v77, v78
    v_lshrrev_b32 v78, 2, v71
    v_add_u32 v78, 84404, v78
    ds_write_b8 v78, v77
    s_waitcnt lgkmcnt(0)
    s_mov_b64 exec, s[62:63]
    s_branch L2_s15_r
L2_s16_o:
    s_mov_b64 s[62:63], exec
    s_mov_b64 s[60:61], vcc
    s_mov_b64 exec, vcc
    v_bfe_u32 v77, v49, 0, 8
    v_lshl_or_b32 v78, v2, 1, 1
L2_s16_l:
    v_lshlrev_b32 v68, 2, v77
    ds_sub_u32 v68, v14 offset:22512
    v_add_u32 v77, v77, v78
    v_and_b32 v77, 0xff, v77
    v_lshlrev_b32 v68, 2, v77
    ds_add_rtn_u32 v68, v68, v14 offset:22512
    s_waitcnt lgkmcnt(0)
    v_cmp_le_u32 vcc, s57, v68
    s_mov_b64 exec, vcc
    s_cbranch_vccnz L2_s16_l
    s_mov_b64 exec, s[60:61]
    v_bfe_u32 v78, v49, 0, 8
    v_xor_b32 v77, v77, v78
    v_lshrrev_b32 v78, 2, v68
    v_add_u32 v78, 84404, v78
    ds_write_b8 v78, v77
    s_waitcnt lgkmcnt(0)
    s_mov_b64 exec, s[62:63]
    s_branch L2_s16_r
L2_p0_o:
    s_andn2_b64 s[62:63], exec, vcc
    s_mov_b64 exec, vcc
    v_lshrrev_b32 v79, 22, v16
    v_lshlrev_b32 v78, 4, v79
    v_lshlrev_b32 v79, 2, v79
    s_waitcnt lgkmcnt(0)
    ds_add_f32 v78, v68 offset:12512
    ds_add_f32 v78, v69 offset:12516
    ds_add_f32 v78, v70 offset:12520
    ds_add_f32 v78, v71 offset:12524
    ds_sub_u32 v79, v3 offset:10000
    s_waitcnt lgkmcnt(0)
    s_mov_b64 exec, s[62:63]
    s_branch L2_p0_r
L2_p1_o:
    s_andn2_b64 s[62:63], exec, vcc
    s_mov_b64 exec, vcc
    v_lshrrev_b32 v79, 22, v17
    v_lshlrev_b32 v78, 4, v79
    v_lshlrev_b32 v79, 2, v79
    s_waitcnt lgkmcnt(0)
    ds_add_f32 v78, v68 offset:12512
    ds_add_f32 v78, v69 offset:12516
    ds_add_f32 v78, v70 offset:12520
    ds_add_f32 v78, v71 offset:12524
    ds_sub_u32 v79, v3 offset:10000
    s_waitcnt lgkmcnt(0)
    s_mov_b64 exec, s[62:63]
    s_branch L2_p1_r
L2_p2_o:
    s_andn2_b64 s[62:63], exec, vcc
    s_mov_b64 exec, vcc
    v_lshrrev_b32 v79, 22, v18
    v_lshlrev_b32 v78, 4, v79
    v_lshlrev_b32 v79, 2, v79
    s_waitcnt lgkmcnt(0)
    ds_add_f32 v78, v68 offset:12512
    ds_add_f32 v78, v69 offset:12516
    ds_add_f32 v78, v70 offset:12520
    ds_add_f32 v78, v71 offset:12524
    ds_sub_u32 v79, v3 offset:10000
    s_waitcnt lgkmcnt(0)
    s_mov_b64 exec, s[62:63]
    s_branch L2_p2_r
L2_p3_o:
    s_andn2_b64 s[62:63], exec, vcc
    s_mov_b64 exec, vcc
    v_lshrrev_b32 v79, 22, v19
    v_lshlrev_b32 v78, 4, v79
    v_lshlrev_b32 v79, 2, v79
    s_waitcnt lgkmcnt(0)
    ds_add_f32 v78, v68 offset:12512
    ds_add_f32 v78, v69 offset:12516
    ds_add_f32 v78, v70 offset:12520
    ds_add_f32 v78, v71 offset:12524
    ds_sub_u32 v79, v3 offset:10000
    s_waitcnt lgkmcnt(0)
    s_mov_b64 exec, s[62:63]
    s_branch L2_p3_r
L2_p4_o:
    s_andn2_b64 s[62:63], exec, vcc
    s_mov_b64 exec, vcc
    v_lshrrev_b32 v79, 22, v20
    v_lshlrev_b32 v78, 4, v79
    v_lshlrev_b32 v79, 2, v79
    s_waitcnt lgkmcnt(0)
    ds_add_f32 v78, v68 offset:12512
    ds_add_f32 v78, v69 offset:12516
    ds_add_f32 v78, v70 offset:12520
    ds_add_f32 v78, v71 offset:12524
    ds_sub_u32 v79, v3 offset:10000
    s_waitcnt lgkmcnt(0)
    s_mov_b64 exec, s[62:63]
    s_branch L2_p4_r
L2_p5_o:
    s_andn2_b64 s[62:63], exec, vcc
    s_mov_b64 exec, vcc
    v_lshrrev_b32 v79, 22, v21
    v_lshlrev_b32 v78, 4, v79
    v_lshlrev_b32 v79, 2, v79
    s_waitcnt lgkmcnt(0)
    ds_add_f32 v78, v68 offset:12512
    ds_add_f32 v78, v69 offset:12516
    ds_add_f32 v78, v70 offset:12520
    ds_add_f32 v78, v71 offset:12524
    ds_sub_u32 v79, v3 offset:10000
    s_waitcnt lgkmcnt(0)
    s_mov_b64 exec, s[62:63]
    s_branch L2_p5_r
L2_p6_o:
    s_andn2_b64 s[62:63], exec, vcc
    s_mov_b64 exec, vcc
    v_lshrrev_b32 v79, 22, v22
    v_lshlrev_b32 v78, 4, v79
    v_lshlrev_b32 v79, 2, v79
    s_waitcnt lgkmcnt(0)
    ds_add_f32 v78, v68 offset:12512
    ds_add_f32 v78, v69 offset:12516
    ds_add_f32 v78, v70 offset:12520
    ds_add_f32 v78, v71 offset:12524
    ds_sub_u32 v79, v3 offset:10000
    s_waitcnt lgkmcnt(0)
    s_mov_b64 exec, s[62:63]
    s_branch L2_p6_r
L2_p7_o:
    s_andn2_b64 s[62:63], exec, vcc
    s_mov_b64 exec, vcc
    v_lshrrev_b32 v79, 22, v23
    v_lshlrev_b32 v78, 4, v79
    v_lshlrev_b32 v79, 2, v79
    s_waitcnt lgkmcnt(0)
    ds_add_f32 v78, v68 offset:12512
    ds_add_f32 v78, v69 offset:12516
    ds_add_f32 v78, v70 offset:12520
    ds_add_f32 v78, v71 offset:12524
    ds_sub_u32 v79, v3 offset:10000
    s_waitcnt lgkmcnt(0)
    s_mov_b64 exec, s[62:63]
    s_branch L2_p7_r
L2_p8_o:
    s_andn2_b64 s[62:63], exec, vcc
    s_mov_b64 exec, vcc
    v_lshrrev_b32 v79, 22, v24
    v_lshlrev_b32 v78, 4, v79
    v_lshlrev_b32 v79, 2, v79
    s_waitcnt lgkmcnt(0)
    ds_add_f32 v78, v68 offset:12512
    ds_add_f32 v78, v69 offset:12516
    ds_add_f32 v78, v70 offset:12520
    ds_add_f32 v78, v71 offset:12524
    ds_sub_u32 v79, v3 offset:10000
    s_waitcnt lgkmcnt(0)
    s_mov_b64 exec, s[62:63]
    s_branch L2_p8_r
L2_p9_o:
    s_andn2_b64 s[62:63], exec, vcc
    s_mov_b64 exec, vcc
    v_lshrrev_b32 v79, 22, v25
    v_lshlrev_b32 v78, 4, v79
    v_lshlrev_b32 v79, 2, v79
    s_waitcnt lgkmcnt(0)
    ds_add_f32 v78, v68 offset:12512
    ds_add_f32 v78, v69 offset:12516
    ds_add_f32 v78, v70 offset:12520
    ds_add_f32 v78, v71 offset:12524
    ds_sub_u32 v79, v3 offset:10000
    s_waitcnt lgkmcnt(0)
    s_mov_b64 exec, s[62:63]
    s_branch L2_p9_r
L2_p10_o:
    s_andn2_b64 s[62:63], exec, vcc
    s_mov_b64 exec, vcc
    v_lshrrev_b32 v79, 22, v26
    v_lshlrev_b32 v78, 4, v79
    v_lshlrev_b32 v79, 2, v79
    s_waitcnt lgkmcnt(0)
    ds_add_f32 v78, v68 offset:12512
    ds_add_f32 v78, v69 offset:12516
    ds_add_f32 v78, v70 offset:12520
    ds_add_f32 v78, v71 offset:12524
    ds_sub_u32 v79, v3 offset:10000
    s_waitcnt lgkmcnt(0)
    s_mov_b64 exec, s[62:63]
    s_branch L2_p10_r
L2_p11_o:
    s_andn2_b64 s[62:63], exec, vcc
    s_mov_b64 exec, vcc
    v_lshrrev_b32 v79, 22, v27
    v_lshlrev_b32 v78, 4, v79
    v_lshlrev_b32 v79, 2, v79
    s_waitcnt lgkmcnt(0)
    ds_add_f32 v78, v68 offset:12512
    ds_add_f32 v78, v69 offset:12516
    ds_add_f32 v78, v70 offset:12520
    ds_add_f32 v78, v71 offset:12524
    ds_sub_u32 v79, v3 offset:10000
    s_waitcnt lgkmcnt(0)
    s_mov_b64 exec, s[62:63]
    s_branch L2_p11_r
L2_p12_o:
    s_andn2_b64 s[62:63], exec, vcc
    s_mov_b64 exec, vcc
    v_lshrrev_b32 v79, 22, v28
    v_lshlrev_b32 v78, 4, v79
    v_lshlrev_b32 v79, 2, v79
    s_waitcnt lgkmcnt(0)
    ds_add_f32 v78, v68 offset:12512
    ds_add_f32 v78, v69 offset:12516
    ds_add_f32 v78, v70 offset:12520
    ds_add_f32 v78, v71 offset:12524
    ds_sub_u32 v79, v3 offset:10000
    s_waitcnt lgkmcnt(0)
    s_mov_b64 exec, s[62:63]
    s_branch L2_p12_r
L2_p13_o:
    s_andn2_b64 s[62:63], exec, vcc
    s_mov_b64 exec, vcc
    v_lshrrev_b32 v79, 22, v29
    v_lshlrev_b32 v78, 4, v79
    v_lshlrev_b32 v79, 2, v79
    s_waitcnt lgkmcnt(0)
    ds_add_f32 v78, v68 offset:12512
    ds_add_f32 v78, v69 offset:12516
    ds_add_f32 v78, v70 offset:12520
    ds_add_f32 v78, v71 offset:12524
    ds_sub_u32 v79, v3 offset:10000
    s_waitcnt lgkmcnt(0)
    s_mov_b64 exec, s[62:63]
    s_branch L2_p13_r
L2_p14_o:
    s_andn2_b64 s[62:63], exec, vcc
    s_mov_b64 exec, vcc
    v_lshrrev_b32 v79, 22, v30
    v_lshlrev_b32 v78, 4, v79
    v_lshlrev_b32 v79, 2, v79
    s_waitcnt lgkmcnt(0)
    ds_add_f32 v78, v68 offset:12512
    ds_add_f32 v78, v69 offset:12516
    ds_add_f32 v78, v70 offset:12520
    ds_add_f32 v78, v71 offset:12524
    ds_sub_u32 v79, v3 offset:10000
    s_waitcnt lgkmcnt(0)
    s_mov_b64 exec, s[62:63]
    s_branch L2_p14_r
L2_p15_o:
    s_andn2_b64 s[62:63], exec, vcc
    s_mov_b64 exec, vcc
    v_lshrrev_b32 v79, 22, v31
    v_lshlrev_b32 v78, 4, v79
    v_lshlrev_b32 v79, 2, v79
    s_waitcnt lgkmcnt(0)
    ds_add_f32 v78, v68 offset:12512
    ds_add_f32 v78, v69 offset:12516
    ds_add_f32 v78, v70 offset:12520
    ds_add_f32 v78, v71 offset:12524
    ds_sub_u32 v79, v3 offset:10000
    s_waitcnt lgkmcnt(0)
    s_mov_b64 exec, s[62:63]
    s_branch L2_p15_r
L2_ps_o:
    s_andn2_b64 s[62:63], exec, vcc
    s_mov_b64 exec, vcc
    v_lshrrev_b32 v79, 22, v48
    v_lshlrev_b32 v78, 4, v79
    v_lshlrev_b32 v79, 2, v79
    s_waitcnt lgkmcnt(0)
    ds_add_f32 v78, v68 offset:12512
    ds_add_f32 v78, v69 offset:12516
    ds_add_f32 v78, v70 offset:12520
    ds_add_f32 v78, v71 offset:12524
    ds_sub_u32 v79, v3 offset:10000
    s_waitcnt lgkmcnt(0)
    s_mov_b64 exec, s[62:63]
    s_branch L2_ps_r
.section .rodata,"a"
.p2align 6
.amdhsa_kernel standalone__molecular_angular_gemnet__graph_kernel
  .amdhsa_next_free_vgpr 112
  .amdhsa_next_free_sgpr 102
  .amdhsa_accum_offset 112
  .amdhsa_group_segment_fixed_size 0
  .amdhsa_kernarg_size 112
  .amdhsa_user_sgpr_count 2
  .amdhsa_user_sgpr_kernarg_segment_ptr 1
  .amdhsa_system_sgpr_workgroup_id_x 1
  .amdhsa_float_denorm_mode_32 3
.end_amdhsa_kernel
```
